```python
import torch

def _softmax(x, axis=-1):
    return torch.softmax(x, dim=axis)
def _gelu(x):
    return torch.nn.functional.gelu(x, approximate="tanh")
def _silu(x):
    return torch.nn.functional.silu(x)
def _sigmoid(x):
    return torch.sigmoid(x)
def _layernorm(x, axis=-1, eps=1e-5):
    m = x.mean(dim=axis, keepdim=True)
    v = x.var(dim=axis, keepdim=True, unbiased=False)
    return (x - m) / torch.sqrt(v + eps)
def _scatter_add(tgt, idx, src, axis=0):
    return tgt.clone().index_add_(axis, idx, src)
def _segment_sum(src, seg, n):
    out = torch.zeros((n,) + src.shape[1:], dtype=src.dtype)
    return out.index_add_(0, seg, src)
def _pad(x, pw):
    flat = tuple(v for pair in reversed(pw) for v in pair)
    return torch.nn.functional.pad(x, flat)

kernel_name = 'parallel_sum__linear_attn_block__glu_gated_swiglu__prompt'

def setup_inputs():

    _w = (lambda a: (lambda t: t.to(torch.bfloat16) if t.is_floating_point() else t)(torch.as_tensor(a)))
    def _A_setup():
        B, S, D = 1, 2048, 512
        return {
            "x": _w((lambda *s: torch.randn(*s, dtype=torch.bfloat16) * 0.05)(B, S, D)),
            "wqkv": _w((lambda *s: torch.randn(*s, dtype=torch.bfloat16) * 0.05)(D, 3 * D)),
            "wo": _w((lambda *s: torch.randn(*s, dtype=torch.bfloat16) * 0.05)(D, D)),
        }
    _A_in = _A_setup()

    def _B_setup():
        B, S, D, F = 1, 2048, 512, 1792
        return {
            "x": _w((lambda *s: torch.randn(*s, dtype=torch.bfloat16) * 0.05)(B, S, D)),
            "w1": _w((lambda *s: torch.randn(*s, dtype=torch.bfloat16) * 0.2)(D, F) * (2.0 / D) ** 0.5),
            "w3": _w((lambda *s: torch.randn(*s, dtype=torch.bfloat16) * 0.2)(D, F) * (2.0 / D) ** 0.5),
            "w2": _w((lambda *s: torch.randn(*s, dtype=torch.bfloat16) * 0.2)(F, D) * (2.0 / F) ** 0.5),
        }
    _B_in = _B_setup()

    return {
        "A_x": _A_in["x"],
        "A_wqkv": _A_in["wqkv"],
        "A_wo": _A_in["wo"],
        "B_x": _B_in["x"],
        "B_w1": _B_in["w1"],
        "B_w3": _B_in["w3"],
        "B_w2": _B_in["w2"],
    }

def reference(A_x, A_wqkv, A_wo, B_x, B_w1, B_w3, B_w2):
    def _A_ref(x, wqkv, wo):
        B, S, D = x.shape
        H = 32; Dh = D // H
        qkv = (lambda x, *d: x.permute(*d))((x @ wqkv).reshape(B, S, 3, H, Dh), 2, 0, 3, 1, 4)
        q, k, v = qkv[0], qkv[1], qkv[2]
        phi = lambda t: torch.where(t > 0, t + 1, torch.exp(t)) + 1e-6
        pq, pk = phi(q), phi(k)
        kv = torch.einsum("bhsd,bhse->bhde", pk, v)
        z = torch.einsum("bhsd->bhd", pk)
        num = torch.einsum("bhqd,bhde->bhqe", pq, kv)
        den = torch.einsum("bhqd,bhd->bhq", pq, z)[..., None] + 1e-6
        o = num / den
        return (lambda x, *d: x.permute(*d))(o, 0, 2, 1, 3).reshape(B, S, D) @ wo

    def _B_ref(x, w1, w3, w2):
        gate = torch.einsum("bsd,df->bsf", x, w1)
        up = torch.einsum("bsd,df->bsf", x, w3)
        h = _silu(gate) * up
        out = torch.einsum("bsf,fd->bsd", h, w2)
        return out

    x = A_x
    xn = _layernorm(x, axis=-1)
    return x + _A_ref(xn, A_wqkv, A_wo) + _B_ref(xn, B_w1, B_w3, B_w2)
```

```asm
; @launch grid=(256,1,1) block=(512,1,1) lds=163840
.amdgcn_target "amdgcn-amd-amdhsa--gfx950"
.text
.globl parallel_sum__linear_attn_block__glu_gated_swiglu__prompt_kernel
.p2align 8
.type parallel_sum__linear_attn_block__glu_gated_swiglu__prompt_kernel,@function
parallel_sum__linear_attn_block__glu_gated_swiglu__prompt_kernel:
    s_cmp_ge_u32 s2, 256
    s_cbranch_scc1 L_end
    s_load_dwordx16 s[80:95], s[0:1], 0
    s_load_dwordx4 s[96:99], s[0:1], 64
    v_lshrrev_b32 v9, 6, v0
    v_and_b32 v1, 63, v0
    v_readfirstlane_b32 s40, v9
    v_lshlrev_b32 v2, 4, v1
    s_and_b32 s41, s40, 3
    s_lshr_b32 s42, s40, 2
    s_xor_b32 s46, s41, s42
    s_and_b32 s52, s2, 7
    s_lshr_b32 s53, s2, 3
    s_and_b32 s43, s52, 1
    s_lshl_b32 s43, s43, 3
    s_and_b32 s54, s53, 7
    s_add_u32 s43, s43, s54
    s_lshr_b32 s44, s52, 1
    s_lshl_b32 s44, s44, 2
    s_lshr_b32 s54, s53, 3
    s_add_u32 s44, s44, s54
    s_lshr_b32 s45, s44, 1
    s_lshl_b32 s64, s52, 2
    s_add_u32 s64, s64, s54
    s_and_b32 s65, s53, 7
    s_lshr_b32 s70, s2, 3
    s_and_b32 s71, s2, 7
    s_lshl_b32 s63, s40, 11
    s_mul_i32 s52, s45, 224
    s_bitcmp1_b32 s45, 0
    s_cselect_b32 s53, 96, 0
    s_cselect_b32 s54, 32, 128
    s_cselect_b32 s55, 0, 192
    s_add_u32 s60, s52, s53
    s_add_u32 s61, s60, 64
    s_add_u32 s62, s52, s54
    s_add_u32 s73, s52, s55
    s_lshl_b32 s47, s43, 17
    s_lshl_b32 s52, s40, 14
    s_add_u32 s47, s47, s52
    v_lshrrev_b32 v9, 3, v1
    v_and_b32 v10, 7, v1
    v_lshrrev_b32 v11, 1, v9
    v_xor_b32 v10, v10, v11
    v_lshlrev_b32 v10, 4, v10
    v_lshlrev_b32 v9, 10, v9
    v_add_u32 v96, v9, v10
    v_xor_b32 v97, 64, v96
    s_waitcnt lgkmcnt(0)
    s_mov_b32 s4, s80
    s_mov_b32 s5, s81
    s_mov_b32 s6, 2097152
    s_mov_b32 s7, 0x20000
    s_mov_b32 s8, s82
    s_mov_b32 s9, s83
    s_mov_b32 s10, 1572864
    s_mov_b32 s11, 0x20000
    s_mov_b32 s12, s88
    s_mov_b32 s13, s89
    s_mov_b32 s14, 1835008
    s_mov_b32 s15, 0x20000
    s_sub_u32 s16, s90, 1024
    s_subb_u32 s17, s91, 0
    s_mov_b32 s18, 1836032
    s_mov_b32 s19, 0x20000
    s_mov_b32 s20, s92
    s_mov_b32 s21, s93
    s_mov_b32 s22, 1835008
    s_mov_b32 s23, 0x20000
    s_mov_b32 s24, s84
    s_mov_b32 s25, s85
    s_mov_b32 s26, 524288
    s_mov_b32 s27, 0x20000
    s_mov_b32 s28, s94
    s_mov_b32 s29, s95
    s_mov_b32 s30, 2097152
    s_mov_b32 s31, 0x20000
    s_mov_b32 s32, s98
    s_mov_b32 s33, s99
    s_mov_b32 s34, 0x10000000
    s_mov_b32 s35, 0x20000
    s_mov_b32 s36, s96
    s_mov_b32 s37, s97
    s_mov_b32 s38, 256
    s_mov_b32 s39, 0x20000
    s_getpc_b64 s[98:99]
    s_and_b32 s98, s98, 0xffffff00
    s_bitcmp1_b32 s44, 0
    s_cbranch_scc1 L_typeB
    v_lshrrev_b32 v3, 3, v1
    v_and_b32 v4, 7, v1
    v_and_b32 v12, 2, v3
    v_xor_b32 v4, v4, v12
    v_lshlrev_b32 v4, 4, v4
    v_mul_u32_u24 v3, 3584, v3
    v_add_u32 v3, v3, v4
    v_xor_b32 v4, 64, v3
    s_mul_i32 s48, s40, 28672
    s_lshl_b32 s77, s60, 1
    s_add_u32 s48, s48, s77
    s_add_u32 m0, s63, 65536
    s_add_u32 s77, s47, 0
    buffer_load_dwordx4 v96, s[4:7], s77 offen lds
    s_add_u32 s77, s47, 7168
    buffer_load_dwordx4 v97, s[4:7], s77 offen offset:1024 lds
    s_add_u32 m0, s63, 0
    s_add_u32 s77, s48, 0
    buffer_load_dwordx4 v3, s[12:15], s77 offen lds
    buffer_load_dwordx4 v4, s[16:19], s77 offen offset:1024 lds
    s_add_u32 m0, s63, 81920
    s_add_u32 s77, s47, 128
    buffer_load_dwordx4 v96, s[4:7], s77 offen lds
    s_add_u32 s77, s47, 7296
    buffer_load_dwordx4 v97, s[4:7], s77 offen offset:1024 lds
    s_add_u32 m0, s63, 16384
    s_add_u32 s77, s48, 229376
    buffer_load_dwordx4 v3, s[12:15], s77 offen lds
    buffer_load_dwordx4 v4, s[16:19], s77 offen offset:1024 lds
    s_or_b32 s52, s2, s40
    s_cmp_lg_u32 s52, 0
    s_cbranch_scc1 L_nononce_A
    s_memrealtime s[74:75]
    s_waitcnt lgkmcnt(0)
    s_or_b32 s52, s74, 1
    v_mov_b32 v9, s52
    v_mov_b32 v10, 0
    buffer_store_dword v9, v10, s[36:39], 0 offen sc1
L_nononce_A:
    s_lshl_b32 s52, s43, 7
    s_lshl_b32 s53, s44, 3
    s_add_u32 s52, s52, s53
    s_add_u32 s52, s52, s40
    s_lshl_b32 s52, s52, 10
    buffer_load_dwordx4 v[104:107], v2, s[4:7], s52 offen
    s_lshl_b32 s52, s43, 2
    s_add_u32 s52, s52, s41
    s_mul_i32 s50, s52, 147456
    s_add_u32 s50, s50, 0
    s_mov_b32 s56, 0xffff0000
    s_mov_b32 s57, 0xffff0000
    s_mul_i32 s66, s43, 36864
    s_lshl_b32 s52, s45, 2
    s_lshl_b32 s53, s42, 1
    s_add_u32 s52, s52, s53
    s_mul_i32 s52, s52, 1152
    s_add_u32 s66, s66, s52
    s_add_u32 s66, s66, 10485760
    s_and_b32 s78, s40, 3
    s_lshr_b32 s79, s40, 2
    s_lshl_b32 s67, s78, 12
    s_lshl_b32 s52, s79, 11
    s_add_u32 s67, s67, s52
    s_lshl_b32 s53, s79, 14
    s_lshl_b32 s54, s65, 7
    s_add_u32 s53, s53, s54
    s_mul_i32 s58, s78, 458752
    s_add_u32 s58, s58, s53
    s_lshl_b32 s59, s78, 17
    s_add_u32 s59, s59, s53
    v_lshrrev_b32 v9, 3, v1
    v_and_b32 v10, 7, v1
    v_and_b32 v11, 2, v9
    v_lshlrev_b32 v11, 1, v11
    v_xor_b32 v10, v10, v11
    v_lshlrev_b32 v10, 4, v10
    v_lshlrev_b32 v9, 10, v9
    v_add_u32 v5, v9, v10
    v_and_b32 v9, 31, v1
    v_lshrrev_b32 v10, 1, v9
    v_and_b32 v10, 7, v10
    v_lshrrev_b32 v11, 5, v1
    s_lshl_b32 s52, s46, 1
    v_xor_b32 v11, s52, v11
    v_xor_b32 v10, v10, v11
    v_lshlrev_b32 v10, 4, v10
    s_lshl_b32 s52, s41, 5
    v_add_u32 v9, s52, v9
    v_lshlrev_b32 v9, 7, v9
    v_add_u32 v9, v9, v10
    v_add_u32 v9, 65536, v9
    v_mov_b32 v98, v9
    v_xor_b32 v99, 32, v9
    v_xor_b32 v100, 64, v9
    v_xor_b32 v101, 96, v9
    v_and_b32 v9, 15, v1
    v_lshrrev_b32 v10, 4, v1
    v_and_b32 v10, 1, v10
    v_lshlrev_b32 v10, 2, v10
    v_cmp_eq_u32 vcc, v9, v10
    v_mov_b32 v11, 0x3f803f80
    v_and_b32 v9, 31, v1
    v_cndmask_b32 v36, 0, v11, vcc
    s_lshl_b32 s52, s42, 6
    v_add_u32 v9, s52, v9
    v_mov_b32 v37, v36
    v_lshlrev_b32 v9, 4, v9
    v_mov_b32 v38, v36
    v_add_u32 v14, 147456, v9
    v_mov_b32 v39, v36
    s_lshl_b32 s52, s41, 2
    v_add_u32 v15, s52, v14
    v_mov_b32 v10, 149504
    v_cmp_gt_u32 vcc, 32, v1
    s_nop 1
    v_cndmask_b32 v15, v10, v15, vcc
    v_lshrrev_b32 v9, 2, v1
    v_and_b32 v9, 3, v9
    v_and_b32 v13, 3, v1
    v_lshlrev_b32 v13, 3, v13
    v_lshrrev_b32 v10, 4, v1
    v_and_b32 v10, 1, v10
    v_lshrrev_b32 v11, 5, v1
    v_lshlrev_b32 v11, 11, v11
    v_add_u32 v13, v13, v11
    v_lshlrev_b32 v11, 10, v10
    v_add_u32 v13, v13, v11
    v_lshlrev_b32 v11, 7, v9
    v_add_u32 v13, v13, v11
    v_lshrrev_b32 v9, 1, v9
    v_lshlrev_b32 v10, 1, v10
    v_or_b32 v9, v9, v10
    s_lshl_b32 s55, s42, 1
    v_xor_b32 v9, s55, v9
    v_lshlrev_b32 v9, 5, v9
    v_add_u32 v13, v13, v9
    s_lshl_b32 s55, s46, 12
    v_add_u32 v13, s55, v13
    v_xor_b32 v24, 0, v13
    v_xor_b32 v25, 4096, v13
    v_xor_b32 v26, 8192, v13
    v_xor_b32 v27, 12288, v13
    v_xor_b32 v28, 32, v13
    v_xor_b32 v29, 4128, v13
    v_xor_b32 v30, 8224, v13
    v_xor_b32 v31, 12320, v13
    s_waitcnt vmcnt(5)
    s_waitcnt lgkmcnt(0)
    s_barrier
    ds_read_b128 v[128:131], v98 offset:0
    ds_read_b64_tr_b16 v[48:49], v24 offset:0
    ds_read_b64_tr_b16 v[50:51], v24 offset:512
    ds_read_b64_tr_b16 v[52:53], v28 offset:0
    ds_read_b64_tr_b16 v[54:55], v28 offset:512
    ds_read_b128 v[132:135], v99 offset:0
    ds_read_b64_tr_b16 v[56:57], v25 offset:0
    ds_read_b64_tr_b16 v[58:59], v25 offset:512
    s_waitcnt lgkmcnt(5)
    v_mfma_f32_16x16x32_bf16 v[40:43], v[36:39], v[48:51], 0
    v_mfma_f32_32x32x16_bf16 v[64:79], v[48:51], v[128:131], 0
    s_add_u32 m0, s63, 98304
    s_add_u32 s77, s47, 256
    buffer_load_dwordx4 v96, s[4:7], s77 offen lds
    s_add_u32 s77, s47, 7424
    v_mov_b32 v9, 0
    buffer_load_dword v120, v9, s[36:39], 0 offen sc1
    s_cmp_lg_u32 s40, 6
    s_cbranch_scc1 L_cpf_A
    s_lshr_b32 s54, s2, 3
    s_mul_i32 s54, s54, 14
    v_add_u32 v9, s54, v1
    v_lshlrev_b32 v9, 7, v9
    v_cmp_gt_u32 vcc, 14, v1
    s_mov_b64 s[68:69], exec
    s_and_b64 exec, exec, vcc
    v_min_u32 v9, L_end-parallel_sum__linear_attn_block__glu_gated_swiglu__prompt_kernel-512, v9
    global_load_dword v41, v9, s[98:99]
    s_mov_b64 exec, s[68:69]
L_cpf_A:
    ds_read_b64_tr_b16 v[60:61], v29 offset:0
    ds_read_b64_tr_b16 v[62:63], v29 offset:512
    s_waitcnt lgkmcnt(5)
    s_nop 0
    v_mfma_f32_16x16x32_bf16 v[44:47], v[36:39], v[52:55], 0
    v_mfma_f32_32x32x16_bf16 v[80:95], v[52:55], v[128:131], 0
    buffer_load_dwordx4 v97, s[4:7], s77 offen offset:1024 lds
    s_add_u32 m0, s63, 32768
    s_add_u32 s77, s48, 458752
    buffer_load_dwordx4 v3, s[12:15], s77 offen lds
    s_waitcnt vmcnt(4)
    v_lshlrev_b32 v108, 16, v104
    v_and_b32 v109, 0xffff0000, v104
    v_add_f32 v112, v108, v109
    v_mul_f32 v113, v108, v108
    ds_read_b128 v[136:139], v100 offset:0
    ds_read_b64_tr_b16 v[48:49], v26 offset:0
    ds_read_b64_tr_b16 v[50:51], v26 offset:512
    s_waitcnt lgkmcnt(5)
    v_mfma_f32_32x32x16_bf16 v[64:79], v[56:59], v[132:135], v[64:79]
    buffer_load_dwordx4 v4, s[16:19], s77 offen offset:1024 lds
    s_add_u32 m0, s63, 114688
    s_add_u32 s77, s47, 384
    buffer_load_dwordx4 v96, s[4:7], s77 offen lds
    v_fmac_f32 v113, v109, v109
    v_lshlrev_b32 v110, 16, v105
    v_and_b32 v111, 0xffff0000, v105
    v_add_f32 v112, v112, v110
    ds_read_b64_tr_b16 v[52:53], v30 offset:0
    ds_read_b64_tr_b16 v[54:55], v30 offset:512
    s_waitcnt lgkmcnt(5)
    v_mfma_f32_32x32x16_bf16 v[80:95], v[60:63], v[132:135], v[80:95]
    s_add_u32 s77, s47, 7552
    buffer_load_dwordx4 v97, s[4:7], s77 offen offset:1024 lds
    s_add_u32 m0, s63, 49152
    s_add_u32 s77, s48, 688128
    v_fmac_f32 v113, v110, v110
    v_add_f32 v112, v112, v111
    v_fmac_f32 v113, v111, v111
    v_lshlrev_b32 v108, 16, v106
    ds_read_b128 v[140:143], v101 offset:0
    ds_read_b64_tr_b16 v[56:57], v27 offset:0
    ds_read_b64_tr_b16 v[58:59], v27 offset:512
    s_waitcnt lgkmcnt(5)
    v_mfma_f32_32x32x16_bf16 v[64:79], v[48:51], v[136:139], v[64:79]
    buffer_load_dwordx4 v3, s[12:15], s77 offen lds
    buffer_load_dwordx4 v4, s[16:19], s77 offen offset:1024 lds
    s_cmp_lg_u32 s40, 4
    s_cbranch_scc1 L_pw_A_4
    v_mul_u32_u24 v12, 3584, v1
    s_and_b32 s49, s43, 7
    s_lshl_b32 s49, s49, 3
    s_add_u32 s49, s49, 256
    s_mul_i32 s49, s49, 3584
    s_lshl_b32 s3, s60, 1
    s_add_u32 s49, s49, s3
    s_mov_b64 exec, 0xff
    buffer_load_dword v41, v12, s[12:15], s49 offen
    buffer_load_dword v41, v12, s[16:19], s49 offen offset:1024
    s_mov_b64 exec, -1
L_pw_A_4:
    v_and_b32 v109, 0xffff0000, v106
    v_add_f32 v112, v112, v108
    v_fmac_f32 v113, v108, v108
    v_add_f32 v112, v112, v109
    ds_read_b64_tr_b16 v[60:61], v31 offset:0
    ds_read_b64_tr_b16 v[62:63], v31 offset:512
    s_waitcnt lgkmcnt(5)
    v_mfma_f32_32x32x16_bf16 v[80:95], v[52:55], v[136:139], v[80:95]
    s_cmp_lg_u32 s40, 0
    s_cbranch_scc1 L_px_A_4
    v_lshlrev_b32 v12, 10, v1
    s_and_b32 s49, s44, 3
    s_lshl_b32 s49, s49, 15
    s_lshl_b32 s3, s43, 17
    s_add_u32 s49, s49, s3
    s_add_u32 s49, s49, 512
    s_mov_b32 exec_hi, 0
    buffer_load_dword v41, v12, s[4:7], s49 offen
    s_mov_b64 exec, -1
L_px_A_4:
    s_cmp_lg_u32 s40, 5
    s_cbranch_scc1 L_pw_A_5
    v_mul_u32_u24 v12, 3584, v1
    s_and_b32 s49, s43, 7
    s_lshl_b32 s49, s49, 3
    s_add_u32 s49, s49, 320
    s_mul_i32 s49, s49, 3584
    s_lshl_b32 s3, s60, 1
    s_add_u32 s49, s49, s3
    s_mov_b64 exec, 0xff
    buffer_load_dword v41, v12, s[12:15], s49 offen
    buffer_load_dword v41, v12, s[16:19], s49 offen offset:1024
    s_mov_b64 exec, -1
L_pw_A_5:
    s_cmp_lg_u32 s40, 1
    s_cbranch_scc1 L_px_A_5
    v_lshlrev_b32 v12, 10, v1
    s_and_b32 s49, s44, 3
    s_lshl_b32 s49, s49, 15
    s_lshl_b32 s3, s43, 17
    s_add_u32 s49, s49, s3
    s_add_u32 s49, s49, 640
    s_mov_b32 exec_hi, 0
    buffer_load_dword v41, v12, s[4:7], s49 offen
    s_mov_b64 exec, -1
L_px_A_5:
    s_barrier
    ds_read_b128 v[144:147], v98 offset:16384
    ds_read_b64_tr_b16 v[48:49], v24 offset:16384
    ds_read_b64_tr_b16 v[50:51], v24 offset:16896
    s_waitcnt lgkmcnt(5)
    v_mfma_f32_32x32x16_bf16 v[64:79], v[56:59], v[140:143], v[64:79]
    s_cmp_lg_u32 s40, 6
    s_cbranch_scc1 L_pw_A_6
    v_mul_u32_u24 v12, 3584, v1
    s_and_b32 s49, s43, 7
    s_lshl_b32 s49, s49, 3
    s_add_u32 s49, s49, 384
    s_mul_i32 s49, s49, 3584
    s_lshl_b32 s3, s60, 1
    s_add_u32 s49, s49, s3
    s_mov_b64 exec, 0xff
    buffer_load_dword v41, v12, s[12:15], s49 offen
    buffer_load_dword v41, v12, s[16:19], s49 offen offset:1024
    s_mov_b64 exec, -1
L_pw_A_6:
    v_fmac_f32 v113, v109, v109
    v_lshlrev_b32 v110, 16, v107
    v_and_b32 v111, 0xffff0000, v107
    v_add_f32 v112, v112, v110
    ds_read_b64_tr_b16 v[52:53], v28 offset:16384
    ds_read_b64_tr_b16 v[54:55], v28 offset:16896
    s_waitcnt lgkmcnt(5)
    v_mfma_f32_32x32x16_bf16 v[80:95], v[60:63], v[140:143], v[80:95]
    s_cmp_lg_u32 s40, 2
    s_cbranch_scc1 L_px_A_6
    v_lshlrev_b32 v12, 10, v1
    s_and_b32 s49, s44, 3
    s_lshl_b32 s49, s49, 15
    s_lshl_b32 s3, s43, 17
    s_add_u32 s49, s49, s3
    s_add_u32 s49, s49, 768
    s_mov_b32 exec_hi, 0
    buffer_load_dword v41, v12, s[4:7], s49 offen
    s_mov_b64 exec, -1
L_px_A_6:
    v_fmac_f32 v113, v110, v110
    v_add_f32 v112, v112, v111
    v_fmac_f32 v113, v111, v111
    s_nop 0
    v_add_f32_dpp v112, v112, v112 quad_perm:[1,0,3,2] row_mask:0xf bank_mask:0xf
    ds_read_b128 v[148:151], v99 offset:16384
    ds_read_b64_tr_b16 v[56:57], v25 offset:16384
    ds_read_b64_tr_b16 v[58:59], v25 offset:16896
    s_waitcnt lgkmcnt(5)
    v_mfma_f32_16x16x32_bf16 v[40:43], v[36:39], v[48:51], v[40:43]
    v_mfma_f32_32x32x16_bf16 v[64:79], v[48:51], v[144:147], v[64:79]
    v_add_f32_dpp v113, v113, v113 quad_perm:[1,0,3,2] row_mask:0xf bank_mask:0xf
    v_add_f32_dpp v112, v112, v112 quad_perm:[2,3,0,1] row_mask:0xf bank_mask:0xf
    s_nop 0
    v_add_f32_dpp v113, v113, v113 quad_perm:[2,3,0,1] row_mask:0xf bank_mask:0xf
    v_add_f32_dpp v112, v112, v112 row_half_mirror row_mask:0xf bank_mask:0xf
    ds_read_b64_tr_b16 v[60:61], v29 offset:16384
    ds_read_b64_tr_b16 v[62:63], v29 offset:16896
    s_waitcnt lgkmcnt(5)
    v_mfma_f32_16x16x32_bf16 v[44:47], v[36:39], v[52:55], v[44:47]
    v_mfma_f32_32x32x16_bf16 v[80:95], v[52:55], v[144:147], v[80:95]
    v_add_f32_dpp v113, v113, v113 row_half_mirror row_mask:0xf bank_mask:0xf
    v_add_f32_dpp v112, v112, v112 row_mirror row_mask:0xf bank_mask:0xf
    s_nop 0
    v_add_f32_dpp v113, v113, v113 row_mirror row_mask:0xf bank_mask:0xf
    v_mov_b32 v108, v112
    ds_read_b128 v[152:155], v100 offset:16384
    ds_read_b64_tr_b16 v[48:49], v26 offset:16384
    ds_read_b64_tr_b16 v[50:51], v26 offset:16896
    s_waitcnt lgkmcnt(5)
    v_mfma_f32_32x32x16_bf16 v[64:79], v[56:59], v[148:151], v[64:79]
    v_mov_b32 v109, v113
    v_permlane16_swap_b32 v112, v108
    s_nop 0
    v_permlane16_swap_b32 v113, v109
    v_add_f32 v112, v112, v108
    ds_read_b64_tr_b16 v[52:53], v30 offset:16384
    ds_read_b64_tr_b16 v[54:55], v30 offset:16896
    s_waitcnt lgkmcnt(5)
    v_mfma_f32_32x32x16_bf16 v[80:95], v[60:63], v[148:151], v[80:95]
    v_add_f32 v113, v113, v109
    v_mov_b32 v108, v112
    v_mov_b32 v109, v113
    s_nop 0
    v_permlane32_swap_b32 v112, v108
    ds_read_b128 v[156:159], v101 offset:16384
    ds_read_b64_tr_b16 v[56:57], v27 offset:16384
    ds_read_b64_tr_b16 v[58:59], v27 offset:16896
    s_waitcnt lgkmcnt(5)
    v_mfma_f32_32x32x16_bf16 v[64:79], v[48:51], v[152:155], v[64:79]
    v_permlane32_swap_b32 v113, v109
    v_add_f32 v112, v112, v108
    v_add_f32 v113, v113, v109
    v_mul_f32 v104, 0x3b000000, v112
    ds_read_b64_tr_b16 v[60:61], v31 offset:16384
    ds_read_b64_tr_b16 v[62:63], v31 offset:16896
    s_waitcnt lgkmcnt(5)
    v_mfma_f32_32x32x16_bf16 v[80:95], v[52:55], v[152:155], v[80:95]
    s_waitcnt vmcnt(4)
    s_barrier
    ds_read_b128 v[160:163], v98 offset:32768
    ds_read_b64_tr_b16 v[48:49], v24 offset:32768
    ds_read_b64_tr_b16 v[50:51], v24 offset:33280
    s_waitcnt lgkmcnt(5)
    v_mfma_f32_32x32x16_bf16 v[64:79], v[56:59], v[156:159], v[64:79]
    s_add_u32 m0, s63, 0
    s_add_u32 s77, s48, 917504
    v_mul_f32 v113, 0x3b000000, v113
    v_fma_f32 v113, -v104, v104, v113
    v_max_f32 v113, 0, v113
    v_add_f32 v107, 0x3727c5ac, v113
    ds_read_b64_tr_b16 v[52:53], v28 offset:32768
    ds_read_b64_tr_b16 v[54:55], v28 offset:33280
    s_waitcnt lgkmcnt(5)
    v_mfma_f32_32x32x16_bf16 v[80:95], v[60:63], v[156:159], v[80:95]
    buffer_load_dwordx4 v3, s[12:15], s77 offen lds
    v_rsq_f32 v105, v107
    v_mov_b32 v108, 2130706432
    v_cmp_eq_u32 vcc, 0, v1
    ds_read_b128 v[164:167], v99 offset:32768
    ds_read_b64_tr_b16 v[56:57], v25 offset:32768
    ds_read_b64_tr_b16 v[58:59], v25 offset:33280
    s_waitcnt lgkmcnt(5)
    v_mfma_f32_16x16x32_bf16 v[40:43], v[36:39], v[48:51], v[40:43]
    v_mfma_f32_32x32x16_bf16 v[64:79], v[48:51], v[160:163], v[64:79]
    buffer_load_dwordx4 v4, s[16:19], s77 offen offset:1024 lds
    v_mov_b32 v109, 0
    v_cndmask_b32 v110, v108, v109, vcc
    s_memrealtime s[74:75]
    v_readfirstlane_b32 s51, v120
    ds_read_b64_tr_b16 v[60:61], v29 offset:32768
    ds_read_b64_tr_b16 v[62:63], v29 offset:33280
    s_waitcnt lgkmcnt(0)
    v_mfma_f32_16x16x32_bf16 v[44:47], v[36:39], v[52:55], v[44:47]
    v_mfma_f32_32x32x16_bf16 v[80:95], v[52:55], v[160:163], v[80:95]
    s_add_u32 m0, s63, 65536
    s_add_u32 s77, s47, 512
    s_mov_b32 s72, 0
    s_waitcnt lgkmcnt(0)
    s_sub_u32 s55, s74, s51
    s_add_u32 s55, s55, 0x100
    s_cmp_eq_u32 s51, 0
    s_cselect_b32 s55, -1, s55
    s_cmp_lt_u32 s55, 0x20000
    s_cbranch_scc1 L_nok_A
L_nloop_A:
    v_mov_b32 v9, 0
    buffer_load_dword v120, v9, s[36:39], 0 offen sc1
    s_waitcnt vmcnt(0)
    s_memrealtime s[74:75]
    v_readfirstlane_b32 s51, v120
    s_add_u32 s72, s72, 1
    s_waitcnt lgkmcnt(0)
    s_cmp_gt_u32 s72, 0x40000
    s_cbranch_scc1 L_nok_A
    s_sub_u32 s55, s74, s51
    s_add_u32 s55, s55, 0x100
    s_cmp_eq_u32 s51, 0
    s_cselect_b32 s55, -1, s55
    s_cmp_lt_u32 s55, 0x20000
    s_cbranch_scc1 L_nok_A
    s_sleep 2
    s_branch L_nloop_A
L_nok_A:
    ds_read_b128 v[168:171], v100 offset:32768
    ds_read_b64_tr_b16 v[48:49], v26 offset:32768
    ds_read_b64_tr_b16 v[50:51], v26 offset:33280
    v_mfma_f32_32x32x16_bf16 v[64:79], v[56:59], v[164:167], v[64:79]
    buffer_load_dwordx4 v96, s[4:7], s77 offen lds
    v_mov_b32 v106, s51
    s_lshl_b32 s54, s43, 7
    s_lshl_b32 s55, s44, 3
    s_add_u32 s54, s54, s55
    s_add_u32 s54, s54, s40
    s_lshl_b32 s54, s54, 4
    s_add_u32 s54, s54, 12599296
    ds_read_b64_tr_b16 v[52:53], v30 offset:32768
    ds_read_b64_tr_b16 v[54:55], v30 offset:33280
    v_mfma_f32_32x32x16_bf16 v[80:95], v[60:63], v[164:167], v[80:95]
    s_add_u32 s77, s47, 7680
    buffer_load_dwordx4 v97, s[4:7], s77 offen offset:1024 lds
    buffer_store_dwordx4 v[104:107], v110, s[32:35], s54 offen sc1
    ds_read_b128 v[172:175], v101 offset:32768
    ds_read_b64_tr_b16 v[56:57], v27 offset:32768
    ds_read_b64_tr_b16 v[58:59], v27 offset:33280
    s_waitcnt lgkmcnt(5)
    v_mfma_f32_32x32x16_bf16 v[64:79], v[48:51], v[168:171], v[64:79]
    s_cmp_lg_u32 s40, 7
    s_cbranch_scc1 L_pw_A_7
    v_mul_u32_u24 v12, 3584, v1
    s_and_b32 s49, s43, 7
    s_lshl_b32 s49, s49, 3
    s_add_u32 s49, s49, 448
    s_mul_i32 s49, s49, 3584
    s_lshl_b32 s3, s60, 1
    s_add_u32 s49, s49, s3
    s_mov_b64 exec, 0xff
    buffer_load_dword v41, v12, s[12:15], s49 offen
    buffer_load_dword v41, v12, s[16:19], s49 offen offset:1024
    s_mov_b64 exec, -1
L_pw_A_7:
    ds_read_b64_tr_b16 v[60:61], v31 offset:32768
    ds_read_b64_tr_b16 v[62:63], v31 offset:33280
    s_waitcnt lgkmcnt(5)
    s_nop 0
    v_mfma_f32_32x32x16_bf16 v[80:95], v[52:55], v[168:171], v[80:95]
    s_cmp_lg_u32 s40, 3
    s_cbranch_scc1 L_px_A_7
    v_lshlrev_b32 v12, 10, v1
    s_and_b32 s49, s44, 3
    s_lshl_b32 s49, s49, 15
    s_lshl_b32 s3, s43, 17
    s_add_u32 s49, s49, s3
    s_add_u32 s49, s49, 896
    s_mov_b32 exec_hi, 0
    buffer_load_dword v41, v12, s[4:7], s49 offen
    s_mov_b64 exec, -1
L_px_A_7:
    s_waitcnt vmcnt(5)
    s_barrier
    ds_read_b128 v[176:179], v98 offset:49152
    ds_read_b64_tr_b16 v[48:49], v24 offset:49152
    ds_read_b64_tr_b16 v[50:51], v24 offset:49664
    s_waitcnt lgkmcnt(5)
    v_mfma_f32_32x32x16_bf16 v[64:79], v[56:59], v[172:175], v[64:79]
    s_add_u32 m0, s63, 16384
    s_add_u32 s77, s48, 1146880
    ds_read_b64_tr_b16 v[52:53], v28 offset:49152
    ds_read_b64_tr_b16 v[54:55], v28 offset:49664
    s_waitcnt lgkmcnt(5)
    v_mfma_f32_32x32x16_bf16 v[80:95], v[60:63], v[172:175], v[80:95]
    buffer_load_dwordx4 v3, s[12:15], s77 offen lds
    ds_read_b128 v[180:183], v99 offset:49152
    ds_read_b64_tr_b16 v[56:57], v25 offset:49152
    ds_read_b64_tr_b16 v[58:59], v25 offset:49664
    s_waitcnt lgkmcnt(5)
    v_mfma_f32_16x16x32_bf16 v[40:43], v[36:39], v[48:51], v[40:43]
    v_mfma_f32_32x32x16_bf16 v[64:79], v[48:51], v[176:179], v[64:79]
    buffer_load_dwordx4 v4, s[16:19], s77 offen offset:1024 lds
    ds_read_b64_tr_b16 v[60:61], v29 offset:49152
    ds_read_b64_tr_b16 v[62:63], v29 offset:49664
    s_waitcnt lgkmcnt(5)
    v_mfma_f32_16x16x32_bf16 v[44:47], v[36:39], v[52:55], v[44:47]
    v_mfma_f32_32x32x16_bf16 v[80:95], v[52:55], v[176:179], v[80:95]
    s_add_u32 m0, s63, 81920
    s_add_u32 s77, s47, 640
    ds_read_b128 v[184:187], v100 offset:49152
    ds_read_b64_tr_b16 v[48:49], v26 offset:49152
    ds_read_b64_tr_b16 v[50:51], v26 offset:49664
    s_waitcnt lgkmcnt(5)
    v_mfma_f32_32x32x16_bf16 v[64:79], v[56:59], v[180:183], v[64:79]
    buffer_load_dwordx4 v96, s[4:7], s77 offen lds
    ds_read_b64_tr_b16 v[52:53], v30 offset:49152
    ds_read_b64_tr_b16 v[54:55], v30 offset:49664
    s_waitcnt lgkmcnt(5)
    v_mfma_f32_32x32x16_bf16 v[80:95], v[60:63], v[180:183], v[80:95]
    s_add_u32 s77, s47, 7808
    buffer_load_dwordx4 v97, s[4:7], s77 offen offset:1024 lds
    ds_read_b128 v[188:191], v101 offset:49152
    ds_read_b64_tr_b16 v[56:57], v27 offset:49152
    ds_read_b64_tr_b16 v[58:59], v27 offset:49664
    s_waitcnt lgkmcnt(5)
    v_mfma_f32_32x32x16_bf16 v[64:79], v[48:51], v[184:187], v[64:79]
    s_cmp_lg_u32 s40, 0
    s_cbranch_scc1 L_pw_A_8
    v_mul_u32_u24 v12, 3584, v1
    s_and_b32 s49, s43, 7
    s_lshl_b32 s49, s49, 3
    s_add_u32 s49, s49, 0
    s_mul_i32 s49, s49, 3584
    s_lshl_b32 s3, s61, 1
    s_add_u32 s49, s49, s3
    s_mov_b64 exec, 0xff
    buffer_load_dword v41, v12, s[12:15], s49 offen
    buffer_load_dword v41, v12, s[16:19], s49 offen offset:1024
    s_mov_b64 exec, -1
L_pw_A_8:
    ds_read_b64_tr_b16 v[60:61], v31 offset:49152
    ds_read_b64_tr_b16 v[62:63], v31 offset:49664
    s_waitcnt lgkmcnt(5)
    s_nop 0
    v_mfma_f32_32x32x16_bf16 v[80:95], v[52:55], v[184:187], v[80:95]
    s_add_u32 m0, s67, 131072
    s_add_u32 s77, s58, 0
    buffer_load_dwordx4 v5, s[20:23], s77 offen lds
    s_add_u32 s77, s58, 7168
    buffer_load_dwordx4 v5, s[20:23], s77 offen offset:1024 lds
    s_waitcnt vmcnt(7)
    s_barrier
    ds_read_b128 v[192:195], v98 offset:0
    ds_read_b64_tr_b16 v[48:49], v24 offset:0
    ds_read_b64_tr_b16 v[50:51], v24 offset:512
    s_waitcnt lgkmcnt(5)
    v_mfma_f32_32x32x16_bf16 v[64:79], v[56:59], v[188:191], v[64:79]
    s_add_u32 m0, s63, 32768
    s_add_u32 s77, s48, 1376256
    ds_read_b64_tr_b16 v[52:53], v28 offset:0
    ds_read_b64_tr_b16 v[54:55], v28 offset:512
    s_waitcnt lgkmcnt(5)
    v_mfma_f32_32x32x16_bf16 v[80:95], v[60:63], v[188:191], v[80:95]
    buffer_load_dwordx4 v3, s[12:15], s77 offen lds
    ds_read_b128 v[196:199], v99 offset:0
    ds_read_b64_tr_b16 v[56:57], v25 offset:0
    ds_read_b64_tr_b16 v[58:59], v25 offset:512
    s_waitcnt lgkmcnt(5)
    v_mfma_f32_16x16x32_bf16 v[40:43], v[36:39], v[48:51], v[40:43]
    v_mfma_f32_32x32x16_bf16 v[64:79], v[48:51], v[192:195], v[64:79]
    buffer_load_dwordx4 v4, s[16:19], s77 offen offset:1024 lds
    ds_read_b64_tr_b16 v[60:61], v29 offset:0
    ds_read_b64_tr_b16 v[62:63], v29 offset:512
    s_waitcnt lgkmcnt(5)
    v_mfma_f32_16x16x32_bf16 v[44:47], v[36:39], v[52:55], v[44:47]
    v_mfma_f32_32x32x16_bf16 v[80:95], v[52:55], v[192:195], v[80:95]
    s_add_u32 m0, s63, 98304
    s_add_u32 s77, s47, 768
    ds_read_b128 v[200:203], v100 offset:0
    ds_read_b64_tr_b16 v[48:49], v26 offset:0
    ds_read_b64_tr_b16 v[50:51], v26 offset:512
    s_waitcnt lgkmcnt(5)
    v_mfma_f32_32x32x16_bf16 v[64:79], v[56:59], v[196:199], v[64:79]
    buffer_load_dwordx4 v96, s[4:7], s77 offen lds
    ds_read_b64_tr_b16 v[52:53], v30 offset:0
    ds_read_b64_tr_b16 v[54:55], v30 offset:512
    s_waitcnt lgkmcnt(5)
    v_mfma_f32_32x32x16_bf16 v[80:95], v[60:63], v[196:199], v[80:95]
    s_add_u32 s77, s47, 7936
    buffer_load_dwordx4 v97, s[4:7], s77 offen offset:1024 lds
    ds_read_b128 v[204:207], v101 offset:0
    ds_read_b64_tr_b16 v[56:57], v27 offset:0
    ds_read_b64_tr_b16 v[58:59], v27 offset:512
    s_waitcnt lgkmcnt(5)
    v_mfma_f32_32x32x16_bf16 v[64:79], v[48:51], v[200:203], v[64:79]
    s_cmp_lg_u32 s40, 1
    s_cbranch_scc1 L_pw_A_9
    v_mul_u32_u24 v12, 3584, v1
    s_and_b32 s49, s43, 7
    s_lshl_b32 s49, s49, 3
    s_add_u32 s49, s49, 64
    s_mul_i32 s49, s49, 3584
    s_lshl_b32 s3, s61, 1
    s_add_u32 s49, s49, s3
    s_mov_b64 exec, 0xff
    buffer_load_dword v41, v12, s[12:15], s49 offen
    buffer_load_dword v41, v12, s[16:19], s49 offen offset:1024
    s_mov_b64 exec, -1
L_pw_A_9:
    ds_read_b64_tr_b16 v[60:61], v31 offset:0
    ds_read_b64_tr_b16 v[62:63], v31 offset:512
    s_waitcnt lgkmcnt(5)
    s_nop 0
    v_mfma_f32_32x32x16_bf16 v[80:95], v[52:55], v[200:203], v[80:95]
    s_waitcnt vmcnt(6)
    s_barrier
    ds_read_b128 v[208:211], v98 offset:16384
    ds_read_b64_tr_b16 v[48:49], v24 offset:16384
    ds_read_b64_tr_b16 v[50:51], v24 offset:16896
    s_waitcnt lgkmcnt(5)
    v_mfma_f32_32x32x16_bf16 v[64:79], v[56:59], v[204:207], v[64:79]
    s_add_u32 m0, s63, 49152
    s_add_u32 s77, s48, 1605632
    ds_read_b64_tr_b16 v[52:53], v28 offset:16384
    ds_read_b64_tr_b16 v[54:55], v28 offset:16896
    s_waitcnt lgkmcnt(5)
    v_mfma_f32_32x32x16_bf16 v[80:95], v[60:63], v[204:207], v[80:95]
    buffer_load_dwordx4 v3, s[12:15], s77 offen lds
    ds_read_b128 v[212:215], v99 offset:16384
    ds_read_b64_tr_b16 v[56:57], v25 offset:16384
    ds_read_b64_tr_b16 v[58:59], v25 offset:16896
    s_waitcnt lgkmcnt(5)
    v_mfma_f32_16x16x32_bf16 v[40:43], v[36:39], v[48:51], v[40:43]
    v_mfma_f32_32x32x16_bf16 v[64:79], v[48:51], v[208:211], v[64:79]
    buffer_load_dwordx4 v4, s[16:19], s77 offen offset:1024 lds
    ds_read_b64_tr_b16 v[60:61], v29 offset:16384
    ds_read_b64_tr_b16 v[62:63], v29 offset:16896
    s_waitcnt lgkmcnt(5)
    v_mfma_f32_16x16x32_bf16 v[44:47], v[36:39], v[52:55], v[44:47]
    v_mfma_f32_32x32x16_bf16 v[80:95], v[52:55], v[208:211], v[80:95]
    s_add_u32 m0, s63, 114688
    s_add_u32 s77, s47, 896
    ds_read_b128 v[216:219], v100 offset:16384
    ds_read_b64_tr_b16 v[48:49], v26 offset:16384
    ds_read_b64_tr_b16 v[50:51], v26 offset:16896
    s_waitcnt lgkmcnt(5)
    v_mfma_f32_32x32x16_bf16 v[64:79], v[56:59], v[212:215], v[64:79]
    buffer_load_dwordx4 v96, s[4:7], s77 offen lds
    ds_read_b64_tr_b16 v[52:53], v30 offset:16384
    ds_read_b64_tr_b16 v[54:55], v30 offset:16896
    s_waitcnt lgkmcnt(5)
    v_mfma_f32_32x32x16_bf16 v[80:95], v[60:63], v[212:215], v[80:95]
    s_add_u32 s77, s47, 8064
    buffer_load_dwordx4 v97, s[4:7], s77 offen offset:1024 lds
    ds_read_b128 v[220:223], v101 offset:16384
    ds_read_b64_tr_b16 v[56:57], v27 offset:16384
    ds_read_b64_tr_b16 v[58:59], v27 offset:16896
    s_waitcnt lgkmcnt(5)
    v_mfma_f32_32x32x16_bf16 v[64:79], v[48:51], v[216:219], v[64:79]
    s_cmp_lg_u32 s40, 2
    s_cbranch_scc1 L_pw_A_10
    v_mul_u32_u24 v12, 3584, v1
    s_and_b32 s49, s43, 7
    s_lshl_b32 s49, s49, 3
    s_add_u32 s49, s49, 128
    s_mul_i32 s49, s49, 3584
    s_lshl_b32 s3, s61, 1
    s_add_u32 s49, s49, s3
    s_mov_b64 exec, 0xff
    buffer_load_dword v41, v12, s[12:15], s49 offen
    buffer_load_dword v41, v12, s[16:19], s49 offen offset:1024
    s_mov_b64 exec, -1
L_pw_A_10:
    ds_read_b64_tr_b16 v[60:61], v31 offset:16384
    ds_read_b64_tr_b16 v[62:63], v31 offset:16896
    s_waitcnt lgkmcnt(5)
    s_nop 0
    v_mfma_f32_32x32x16_bf16 v[80:95], v[52:55], v[216:219], v[80:95]
    s_waitcnt vmcnt(4)
    s_barrier
    ds_read_b128 v[224:227], v98 offset:32768
    ds_read_b64_tr_b16 v[48:49], v24 offset:32768
    ds_read_b64_tr_b16 v[50:51], v24 offset:33280
    s_waitcnt lgkmcnt(5)
    v_mfma_f32_32x32x16_bf16 v[64:79], v[56:59], v[220:223], v[64:79]
    v_lshrrev_b32 v3, 3, v1
    v_and_b32 v9, 31, v1
    v_lshlrev_b32 v9, 4, v9
    s_lshl_b32 s54, s43, 7
    s_lshl_b32 s55, s41, 5
    s_add_u32 s54, s54, s55
    s_lshl_b32 s54, s54, 4
    ds_read_b64_tr_b16 v[52:53], v28 offset:32768
    ds_read_b64_tr_b16 v[54:55], v28 offset:33280
    s_waitcnt lgkmcnt(5)
    v_mfma_f32_32x32x16_bf16 v[80:95], v[60:63], v[220:223], v[80:95]
    v_and_b32 v4, 7, v1
    s_add_u32 s54, s54, 12599296
    buffer_load_dwordx4 v[32:35], v9, s[32:35], s54 offen sc1
    ds_read_b128 v[228:231], v99 offset:32768
    ds_read_b64_tr_b16 v[56:57], v25 offset:32768
    ds_read_b64_tr_b16 v[58:59], v25 offset:33280
    s_waitcnt lgkmcnt(5)
    v_mfma_f32_16x16x32_bf16 v[40:43], v[36:39], v[48:51], v[40:43]
    v_mfma_f32_32x32x16_bf16 v[64:79], v[48:51], v[224:227], v[64:79]
    v_and_b32 v12, 2, v3
    ds_read_b64_tr_b16 v[60:61], v29 offset:32768
    ds_read_b64_tr_b16 v[62:63], v29 offset:33280
    s_waitcnt lgkmcnt(5)
    v_mfma_f32_16x16x32_bf16 v[44:47], v[36:39], v[52:55], v[44:47]
    v_mfma_f32_32x32x16_bf16 v[80:95], v[52:55], v[224:227], v[80:95]
    v_xor_b32 v4, v4, v12
    ds_read_b128 v[232:235], v100 offset:32768
    ds_read_b64_tr_b16 v[48:49], v26 offset:32768
    ds_read_b64_tr_b16 v[50:51], v26 offset:33280
    s_waitcnt lgkmcnt(5)
    v_mfma_f32_32x32x16_bf16 v[64:79], v[56:59], v[228:231], v[64:79]
    v_lshlrev_b32 v4, 4, v4
    ds_read_b64_tr_b16 v[52:53], v30 offset:32768
    ds_read_b64_tr_b16 v[54:55], v30 offset:33280
    s_waitcnt lgkmcnt(5)
    v_mfma_f32_32x32x16_bf16 v[80:95], v[60:63], v[228:231], v[80:95]
    v_mul_u32_u24 v3, 3584, v3
    ds_read_b128 v[236:239], v101 offset:32768
    ds_read_b64_tr_b16 v[56:57], v27 offset:32768
    ds_read_b64_tr_b16 v[58:59], v27 offset:33280
    s_waitcnt lgkmcnt(5)
    v_mfma_f32_32x32x16_bf16 v[64:79], v[48:51], v[232:235], v[64:79]
    v_add_u32 v3, v3, v4
    ds_read_b64_tr_b16 v[60:61], v31 offset:32768
    ds_read_b64_tr_b16 v[62:63], v31 offset:33280
    s_waitcnt lgkmcnt(5)
    v_mfma_f32_32x32x16_bf16 v[80:95], v[52:55], v[232:235], v[80:95]
    v_xor_b32 v4, 64, v3
    s_mul_i32 s48, s40, 28672
    s_lshl_b32 s77, s61, 1
    s_add_u32 s48, s48, s77
    s_add_u32 m0, s63, 0
    s_add_u32 s77, s48, 0
    buffer_load_dwordx4 v3, s[12:15], s77 offen lds
    buffer_load_dwordx4 v4, s[16:19], s77 offen offset:1024 lds
    s_cmp_lg_u32 s40, 3
    s_cbranch_scc1 L_pw_A_11
    v_mul_u32_u24 v12, 3584, v1
    s_and_b32 s49, s43, 7
    s_lshl_b32 s49, s49, 3
    s_add_u32 s49, s49, 192
    s_mul_i32 s49, s49, 3584
    s_lshl_b32 s3, s61, 1
    s_add_u32 s49, s49, s3
    s_mov_b64 exec, 0xff
    buffer_load_dword v41, v12, s[12:15], s49 offen
    buffer_load_dword v41, v12, s[16:19], s49 offen offset:1024
    s_mov_b64 exec, -1
L_pw_A_11:
    s_waitcnt vmcnt(3)
    s_barrier
    ds_read_b128 v[240:243], v98 offset:49152
    ds_read_b64_tr_b16 v[48:49], v24 offset:49152
    ds_read_b64_tr_b16 v[50:51], v24 offset:49664
    s_waitcnt lgkmcnt(5)
    v_mfma_f32_32x32x16_bf16 v[64:79], v[56:59], v[236:239], v[64:79]
    s_add_u32 m0, s63, 16384
    s_add_u32 s77, s48, 229376
    ds_read_b64_tr_b16 v[52:53], v28 offset:49152
    ds_read_b64_tr_b16 v[54:55], v28 offset:49664
    s_waitcnt lgkmcnt(5)
    v_mfma_f32_32x32x16_bf16 v[80:95], v[60:63], v[236:239], v[80:95]
    buffer_load_dwordx4 v3, s[12:15], s77 offen lds
    ds_read_b128 v[244:247], v99 offset:49152
    ds_read_b64_tr_b16 v[56:57], v25 offset:49152
    ds_read_b64_tr_b16 v[58:59], v25 offset:49664
    s_waitcnt lgkmcnt(5)
    v_mfma_f32_16x16x32_bf16 v[40:43], v[36:39], v[48:51], v[40:43]
    v_mfma_f32_32x32x16_bf16 v[64:79], v[48:51], v[240:243], v[64:79]
    buffer_load_dwordx4 v4, s[16:19], s77 offen offset:1024 lds
    ds_read_b64_tr_b16 v[60:61], v29 offset:49152
    ds_read_b64_tr_b16 v[62:63], v29 offset:49664
    s_waitcnt lgkmcnt(5)
    v_mfma_f32_16x16x32_bf16 v[44:47], v[36:39], v[52:55], v[44:47]
    v_mfma_f32_32x32x16_bf16 v[80:95], v[52:55], v[240:243], v[80:95]
    s_cmp_lg_u32 s40, 4
    s_cbranch_scc1 L_pw_A_12
    v_mul_u32_u24 v12, 3584, v1
    s_and_b32 s49, s43, 7
    s_lshl_b32 s49, s49, 3
    s_add_u32 s49, s49, 256
    s_mul_i32 s49, s49, 3584
    s_lshl_b32 s3, s61, 1
    s_add_u32 s49, s49, s3
    s_mov_b64 exec, 0xff
    buffer_load_dword v41, v12, s[12:15], s49 offen
    buffer_load_dword v41, v12, s[16:19], s49 offen offset:1024
    s_mov_b64 exec, -1
L_pw_A_12:
    ds_write_b32 v15, v40 offset:0
    s_nop 3
    ds_write_b32 v15, v44 offset:512
    ds_read_b128 v[248:251], v100 offset:49152
    ds_read_b64_tr_b16 v[48:49], v26 offset:49152
    ds_read_b64_tr_b16 v[50:51], v26 offset:49664
    s_waitcnt lgkmcnt(7)
    v_mfma_f32_32x32x16_bf16 v[64:79], v[56:59], v[244:247], v[64:79]
    ds_read_b64_tr_b16 v[52:53], v30 offset:49152
    ds_read_b64_tr_b16 v[54:55], v30 offset:49664
    s_waitcnt lgkmcnt(7)
    v_mfma_f32_32x32x16_bf16 v[80:95], v[60:63], v[244:247], v[80:95]
    ds_read_b128 v[252:255], v101 offset:49152
    ds_read_b64_tr_b16 v[56:57], v27 offset:49152
    ds_read_b64_tr_b16 v[58:59], v27 offset:49664
    s_waitcnt lgkmcnt(5)
    v_mfma_f32_32x32x16_bf16 v[64:79], v[48:51], v[248:251], v[64:79]
    ds_read_b64_tr_b16 v[60:61], v31 offset:49152
    ds_read_b64_tr_b16 v[62:63], v31 offset:49664
    s_waitcnt lgkmcnt(5)
    v_mfma_f32_32x32x16_bf16 v[80:95], v[52:55], v[248:251], v[80:95]
    s_waitcnt vmcnt(2)
    s_waitcnt lgkmcnt(0)
    s_barrier
    ds_read_b64_tr_b16 v[48:49], v24 offset:0
    ds_read_b64_tr_b16 v[50:51], v24 offset:512
    v_mfma_f32_32x32x16_bf16 v[64:79], v[56:59], v[252:255], v[64:79]
    s_add_u32 m0, s63, 32768
    s_add_u32 s77, s48, 458752
    v_cmp_eq_u32 vcc, s51, v34
    s_mov_b32 s72, 0
    s_nop 1
    s_cmp_eq_u64 vcc, exec
    s_cbranch_scc1 L_sok_A
    v_and_b32 v9, 31, v1
    v_lshlrev_b32 v9, 4, v9
    s_lshl_b32 s54, s43, 7
    s_lshl_b32 s55, s41, 5
    s_add_u32 s54, s54, s55
    s_lshl_b32 s54, s54, 4
    s_add_u32 s54, s54, 12599296
L_sloop_A:
    buffer_load_dwordx4 v[32:35], v9, s[32:35], s54 offen sc1
    s_waitcnt vmcnt(0)
    v_cmp_eq_u32 vcc, s51, v34
    s_add_u32 s72, s72, 1
    s_cmp_gt_u32 s72, 0x80000
    s_cbranch_scc1 L_sok_A
    s_cmp_eq_u64 vcc, exec
    s_cbranch_scc1 L_sok_A
    s_sleep 4
    s_branch L_sloop_A
L_sok_A:
    ds_read_b64_tr_b16 v[52:53], v28 offset:0
    ds_read_b64_tr_b16 v[54:55], v28 offset:512
    v_mfma_f32_32x32x16_bf16 v[80:95], v[60:63], v[252:255], v[80:95]
    buffer_load_dwordx4 v3, s[12:15], s77 offen lds
    v_and_b32 v22, 31, v1
    s_lshl_b32 s55, s41, 5
    v_add_u32 v22, s55, v22
    v_lshlrev_b32 v22, 2, v22
    v_add_u32 v22, 153600, v22
    ds_read_b64_tr_b16 v[56:57], v25 offset:0
    ds_read_b64_tr_b16 v[58:59], v25 offset:512
    s_waitcnt lgkmcnt(4)
    v_mfma_f32_16x16x32_bf16 v[40:43], v[36:39], v[48:51], 0
    v_mfma_f32_32x32x16_bf16 v[96:111], v[48:51], v[128:131], 0
    buffer_load_dwordx4 v4, s[16:19], s77 offen offset:1024 lds
    v_mov_b32 v8, v33
    v_cvt_pk_bf16_f32 v18, -v32, -v32
    v_mul_f32 v6, 0xbfb8aa3b, v33
    v_mul_f32 v17, v35, v33
    v_mul_f32 v7, 0xbfb8aa3b, v17
    v_and_b32 v19, 0xffff0000, v18
    v_sub_f32 v19, -v32, v19
    ds_read_b64_tr_b16 v[60:61], v29 offset:0
    ds_read_b64_tr_b16 v[62:63], v29 offset:512
    s_waitcnt lgkmcnt(4)
    v_mfma_f32_16x16x32_bf16 v[44:47], v[36:39], v[52:55], 0
    v_mfma_f32_32x32x16_bf16 v[112:127], v[52:55], v[128:131], 0
    s_cmp_lg_u32 s40, 5
    s_cbranch_scc1 L_pw_A_13
    v_mul_u32_u24 v12, 3584, v1
    s_and_b32 s49, s43, 7
    s_lshl_b32 s49, s49, 3
    s_add_u32 s49, s49, 320
    s_mul_i32 s49, s49, 3584
    s_lshl_b32 s3, s61, 1
    s_add_u32 s49, s49, s3
    s_mov_b64 exec, 0xff
    buffer_load_dword v41, v12, s[12:15], s49 offen
    buffer_load_dword v41, v12, s[16:19], s49 offen offset:1024
    s_mov_b64 exec, -1
L_pw_A_13:
    v_cvt_pk_bf16_f32 v33, -v32, 0
    v_cvt_pk_bf16_f32 v32, -v32, v19
    v_cmp_gt_u32 vcc, 32, v1
    v_sub_f32 v20, 0, v6
    s_nop 0
    v_cndmask_b32 v32, 0, v32, vcc
    v_cndmask_b32 v33, 0, v33, vcc
    v_mov_b32 v34, 0
    ds_read_b64_tr_b16 v[48:49], v26 offset:0
    ds_read_b64_tr_b16 v[50:51], v26 offset:512
    s_waitcnt lgkmcnt(4)
    v_mfma_f32_32x32x16_bf16 v[96:111], v[56:59], v[132:135], v[96:111]
    s_cmp_lt_u32 s40, 6
    s_cbranch_scc1 L_mt_A
    v_lshlrev_b32 v12, 7, v1
    s_mov_b64 s[68:69], exec
    s_cmp_eq_u32 s40, 7
    s_cbranch_scc1 L_mt_A_o
    s_mul_i32 s49, s2, 7168
    s_mov_b32 exec_hi, 0x00ffffff
    buffer_load_dword v41, v12, s[20:23], s49 offen
    s_branch L_mt_A_e
L_mt_A_o:
    s_lshl_b32 s49, s2, 11
    s_mov_b64 exec, 0xffff
    buffer_load_dword v41, v12, s[24:27], s49 offen
L_mt_A_e:
    s_mov_b64 exec, s[68:69]
L_mt_A:
    v_mov_b32 v35, 0
    ds_write_b32 v22, v20
    ds_read_b128 v[16:19], v14 offset:0
    s_waitcnt lgkmcnt(0)
    v_add_f32 v16, v16, v17
    v_add_f32 v18, v18, v19
    v_mov_b32 v22, 0
    v_add_f32 v16, v16, v18
    ds_read_b64_tr_b16 v[52:53], v30 offset:0
    ds_read_b64_tr_b16 v[54:55], v30 offset:512
    v_mfma_f32_32x32x16_bf16 v[112:127], v[60:63], v[132:135], v[112:127]
    v_mov_b32 v23, 0
    v_cvt_pk_bf16_f32 v20, v16, v16
    v_and_b32 v17, 0xffff0000, v20
    v_sub_f32 v16, v16, v17
    v_cvt_pk_bf16_f32 v21, v16, 0
    s_nop 1
    v_mfma_f32_32x32x16_bf16 v[64:79], v[20:23], v[32:35], v[64:79]
    ds_read_b64_tr_b16 v[56:57], v27 offset:0
    ds_read_b64_tr_b16 v[58:59], v27 offset:512
    v_mfma_f32_32x32x16_bf16 v[96:111], v[48:51], v[136:139], v[96:111]
    ds_read_b128 v[16:19], v14 offset:512
    s_waitcnt lgkmcnt(0)
    v_add_f32 v16, v16, v17
    v_add_f32 v18, v18, v19
    v_mov_b32 v22, 0
    v_add_f32 v16, v16, v18
    v_mov_b32 v23, 0
    v_cvt_pk_bf16_f32 v20, v16, v16
    ds_read_b64_tr_b16 v[60:61], v31 offset:0
    ds_read_b64_tr_b16 v[62:63], v31 offset:512
    v_mfma_f32_32x32x16_bf16 v[112:127], v[52:55], v[136:139], v[112:127]
    s_waitcnt vmcnt(2)
    s_barrier
    ds_read_b64_tr_b16 v[48:49], v24 offset:16384
    ds_read_b64_tr_b16 v[50:51], v24 offset:16896
    v_mfma_f32_32x32x16_bf16 v[96:111], v[56:59], v[140:143], v[96:111]
    s_add_u32 m0, s63, 49152
    s_add_u32 s77, s48, 688128
    v_and_b32 v17, 0xffff0000, v20
    v_sub_f32 v16, v16, v17
    v_cvt_pk_bf16_f32 v21, v16, 0
    s_nop 1
    v_mfma_f32_32x32x16_bf16 v[80:95], v[20:23], v[32:35], v[80:95]
    ds_read_b64_tr_b16 v[52:53], v28 offset:16384
    ds_read_b64_tr_b16 v[54:55], v28 offset:16896
    s_waitcnt lgkmcnt(4)
    v_mfma_f32_32x32x16_bf16 v[112:127], v[60:63], v[140:143], v[112:127]
    buffer_load_dwordx4 v3, s[12:15], s77 offen lds
    v_mul_f32 v64, v6, v64
    v_mul_f32 v65, v6, v65
    v_mul_f32 v66, v6, v66
    v_mul_f32 v67, v6, v67
    v_exp_f32 v16, v64
    v_exp_f32 v17, v65
    ds_read_b64_tr_b16 v[56:57], v25 offset:16384
    ds_read_b64_tr_b16 v[58:59], v25 offset:16896
    s_waitcnt lgkmcnt(4)
    v_mfma_f32_16x16x32_bf16 v[40:43], v[36:39], v[48:51], v[40:43]
    v_mfma_f32_32x32x16_bf16 v[96:111], v[48:51], v[144:147], v[96:111]
    buffer_load_dwordx4 v4, s[16:19], s77 offen offset:1024 lds
    v_exp_f32 v18, v66
    v_exp_f32 v19, v67
    v_mul_f32 v72, v72, v64
    v_mul_f32 v73, v73, v65
    v_mul_f32 v74, v74, v66
    ds_read_b64_tr_b16 v[60:61], v29 offset:16384
    ds_read_b64_tr_b16 v[62:63], v29 offset:16896
    s_waitcnt lgkmcnt(4)
    v_mfma_f32_16x16x32_bf16 v[44:47], v[36:39], v[52:55], v[44:47]
    v_mfma_f32_32x32x16_bf16 v[112:127], v[52:55], v[144:147], v[112:127]
    s_cmp_lg_u32 s40, 6
    s_cbranch_scc1 L_pw_A_14
    v_mul_u32_u24 v12, 3584, v1
    s_and_b32 s49, s43, 7
    s_lshl_b32 s49, s49, 3
    s_add_u32 s49, s49, 384
    s_mul_i32 s49, s49, 3584
    s_lshl_b32 s3, s61, 1
    s_add_u32 s49, s49, s3
    s_mov_b64 exec, 0xff
    buffer_load_dword v41, v12, s[12:15], s49 offen
    buffer_load_dword v41, v12, s[16:19], s49 offen offset:1024
    s_mov_b64 exec, -1
L_pw_A_14:
    v_mul_f32 v75, v75, v67
    v_fma_f32 v16, v16, v7, v7
    v_fma_f32 v17, v17, v7, v7
    v_fma_f32 v18, v18, v7, v7
    v_fma_f32 v19, v19, v7, v7
    v_rcp_f32 v16, v16
    ds_read_b64_tr_b16 v[48:49], v26 offset:16384
    ds_read_b64_tr_b16 v[50:51], v26 offset:16896
    s_waitcnt lgkmcnt(4)
    v_mfma_f32_32x32x16_bf16 v[96:111], v[56:59], v[148:151], v[96:111]
    s_add_u32 m0, s67, 65536
    s_add_u32 s77, s58, 32768
    v_rcp_f32 v17, v17
    v_rcp_f32 v18, v18
    v_rcp_f32 v19, v19
    v_mul_f32 v64, v72, v16
    ds_read_b64_tr_b16 v[52:53], v30 offset:16384
    ds_read_b64_tr_b16 v[54:55], v30 offset:16896
    s_waitcnt lgkmcnt(4)
    v_mfma_f32_32x32x16_bf16 v[112:127], v[60:63], v[148:151], v[112:127]
    buffer_load_dwordx4 v5, s[20:23], s77 offen lds
    v_mul_f32 v65, v73, v17
    v_mul_f32 v66, v74, v18
    v_mul_f32 v67, v75, v19
    v_mul_f32 v68, v6, v68
    v_mul_f32 v69, v6, v69
    v_mul_f32 v70, v6, v70
    v_mul_f32 v71, v6, v71
    ds_read_b64_tr_b16 v[56:57], v27 offset:16384
    ds_read_b64_tr_b16 v[58:59], v27 offset:16896
    s_waitcnt lgkmcnt(4)
    v_mfma_f32_32x32x16_bf16 v[96:111], v[48:51], v[152:155], v[96:111]
    s_add_u32 s77, s58, 39936
    buffer_load_dwordx4 v5, s[20:23], s77 offen offset:1024 lds
    v_exp_f32 v16, v68
    v_exp_f32 v17, v69
    v_exp_f32 v18, v70
    v_exp_f32 v19, v71
    ds_read_b64_tr_b16 v[60:61], v31 offset:16384
    ds_read_b64_tr_b16 v[62:63], v31 offset:16896
    s_waitcnt lgkmcnt(4)
    v_mfma_f32_32x32x16_bf16 v[112:127], v[52:55], v[152:155], v[112:127]
    s_waitcnt vmcnt(4)
    s_barrier
    ds_read_b64_tr_b16 v[48:49], v24 offset:32768
    ds_read_b64_tr_b16 v[50:51], v24 offset:33280
    s_waitcnt lgkmcnt(4)
    v_mfma_f32_32x32x16_bf16 v[96:111], v[56:59], v[156:159], v[96:111]
    s_add_u32 m0, s63, 0
    s_add_u32 s77, s48, 917504
    v_mul_f32 v76, v76, v68
    v_mul_f32 v77, v77, v69
    v_mul_f32 v78, v78, v70
    v_mul_f32 v79, v79, v71
    v_fma_f32 v16, v16, v7, v7
    v_fma_f32 v17, v17, v7, v7
    v_fma_f32 v18, v18, v7, v7
    ds_read_b64_tr_b16 v[52:53], v28 offset:32768
    ds_read_b64_tr_b16 v[54:55], v28 offset:33280
    s_waitcnt lgkmcnt(4)
    v_mfma_f32_32x32x16_bf16 v[112:127], v[60:63], v[156:159], v[112:127]
    buffer_load_dwordx4 v3, s[12:15], s77 offen lds
    v_fma_f32 v19, v19, v7, v7
    v_rcp_f32 v16, v16
    v_rcp_f32 v17, v17
    v_rcp_f32 v18, v18
    ds_read_b64_tr_b16 v[56:57], v25 offset:32768
    ds_read_b64_tr_b16 v[58:59], v25 offset:33280
    s_waitcnt lgkmcnt(4)
    v_mfma_f32_16x16x32_bf16 v[40:43], v[36:39], v[48:51], v[40:43]
    v_mfma_f32_32x32x16_bf16 v[96:111], v[48:51], v[160:163], v[96:111]
    buffer_load_dwordx4 v4, s[16:19], s77 offen offset:1024 lds
    v_rcp_f32 v19, v19
    v_mul_f32 v68, v76, v16
    v_mul_f32 v69, v77, v17
    v_mul_f32 v70, v78, v18
    v_mul_f32 v71, v79, v19
    v_cvt_pk_bf16_f32 v64, v64, v65
    ds_read_b64_tr_b16 v[60:61], v29 offset:32768
    ds_read_b64_tr_b16 v[62:63], v29 offset:33280
    s_waitcnt lgkmcnt(4)
    v_mfma_f32_16x16x32_bf16 v[44:47], v[36:39], v[52:55], v[44:47]
    v_mfma_f32_32x32x16_bf16 v[112:127], v[52:55], v[160:163], v[112:127]
    s_cmp_lg_u32 s40, 7
    s_cbranch_scc1 L_pw_A_15
    v_mul_u32_u24 v12, 3584, v1
    s_and_b32 s49, s43, 7
    s_lshl_b32 s49, s49, 3
    s_add_u32 s49, s49, 448
    s_mul_i32 s49, s49, 3584
    s_lshl_b32 s3, s61, 1
    s_add_u32 s49, s49, s3
    s_mov_b64 exec, 0xff
    buffer_load_dword v41, v12, s[12:15], s49 offen
    buffer_load_dword v41, v12, s[16:19], s49 offen offset:1024
    s_mov_b64 exec, -1
L_pw_A_15:
    v_cvt_pk_bf16_f32 v65, v66, v67
    v_cvt_pk_bf16_f32 v66, v68, v69
    v_cvt_pk_bf16_f32 v67, v70, v71
    s_lshr_b32 s54, s60, 4
    s_mul_i32 s55, s42, 2
    s_add_u32 s54, s54, s55
    s_add_u32 s54, s54, 0
    s_lshl_b32 s54, s54, 10
    s_add_u32 s54, s54, s50
    buffer_store_dwordx4 v[64:67], v2, s[32:35], s54 offen sc1
    ds_read_b64_tr_b16 v[48:49], v26 offset:32768
    ds_read_b64_tr_b16 v[50:51], v26 offset:33280
    s_waitcnt lgkmcnt(4)
    v_mfma_f32_32x32x16_bf16 v[96:111], v[56:59], v[164:167], v[96:111]
    v_mul_f32 v80, v6, v80
    v_mul_f32 v81, v6, v81
    v_mul_f32 v82, v6, v82
    v_mul_f32 v83, v6, v83
    v_exp_f32 v16, v80
    v_exp_f32 v17, v81
    ds_read_b64_tr_b16 v[52:53], v30 offset:32768
    ds_read_b64_tr_b16 v[54:55], v30 offset:33280
    s_waitcnt lgkmcnt(4)
    v_mfma_f32_32x32x16_bf16 v[112:127], v[60:63], v[164:167], v[112:127]
    v_exp_f32 v18, v82
    v_exp_f32 v19, v83
    v_mul_f32 v88, v88, v80
    v_mul_f32 v89, v89, v81
    v_mul_f32 v90, v90, v82
    ds_read_b64_tr_b16 v[56:57], v27 offset:32768
    ds_read_b64_tr_b16 v[58:59], v27 offset:33280
    s_waitcnt lgkmcnt(4)
    v_mfma_f32_32x32x16_bf16 v[96:111], v[48:51], v[168:171], v[96:111]
    v_mul_f32 v91, v91, v83
    v_fma_f32 v16, v16, v7, v7
    v_fma_f32 v17, v17, v7, v7
    v_fma_f32 v18, v18, v7, v7
    v_fma_f32 v19, v19, v7, v7
    v_rcp_f32 v16, v16
    ds_read_b64_tr_b16 v[60:61], v31 offset:32768
    ds_read_b64_tr_b16 v[62:63], v31 offset:33280
    s_waitcnt lgkmcnt(4)
    v_mfma_f32_32x32x16_bf16 v[112:127], v[52:55], v[168:171], v[112:127]
    s_waitcnt vmcnt(5)
    s_barrier
    ds_read_b64_tr_b16 v[48:49], v24 offset:49152
    ds_read_b64_tr_b16 v[50:51], v24 offset:49664
    s_waitcnt lgkmcnt(4)
    v_mfma_f32_32x32x16_bf16 v[96:111], v[56:59], v[172:175], v[96:111]
    s_add_u32 m0, s63, 16384
    s_add_u32 s77, s48, 1146880
    v_rcp_f32 v17, v17
    v_rcp_f32 v18, v18
    v_rcp_f32 v19, v19
    v_mul_f32 v80, v88, v16
    ds_read_b64_tr_b16 v[52:53], v28 offset:49152
    ds_read_b64_tr_b16 v[54:55], v28 offset:49664
    s_waitcnt lgkmcnt(4)
    v_mfma_f32_32x32x16_bf16 v[112:127], v[60:63], v[172:175], v[112:127]
    buffer_load_dwordx4 v3, s[12:15], s77 offen lds
    v_mul_f32 v81, v89, v17
    v_mul_f32 v82, v90, v18
    v_mul_f32 v83, v91, v19
    v_mul_f32 v84, v6, v84
    v_mul_f32 v85, v6, v85
    v_mul_f32 v86, v6, v86
    v_mul_f32 v87, v6, v87
    ds_read_b64_tr_b16 v[56:57], v25 offset:49152
    ds_read_b64_tr_b16 v[58:59], v25 offset:49664
    s_waitcnt lgkmcnt(4)
    v_mfma_f32_16x16x32_bf16 v[40:43], v[36:39], v[48:51], v[40:43]
    v_mfma_f32_32x32x16_bf16 v[96:111], v[48:51], v[176:179], v[96:111]
    buffer_load_dwordx4 v4, s[16:19], s77 offen offset:1024 lds
    v_exp_f32 v16, v84
    v_exp_f32 v17, v85
    v_exp_f32 v18, v86
    v_exp_f32 v19, v87
    ds_read_b64_tr_b16 v[60:61], v29 offset:49152
    ds_read_b64_tr_b16 v[62:63], v29 offset:49664
    s_waitcnt lgkmcnt(4)
    v_mfma_f32_16x16x32_bf16 v[44:47], v[36:39], v[52:55], v[44:47]
    v_mfma_f32_32x32x16_bf16 v[112:127], v[52:55], v[176:179], v[112:127]
    s_cmp_lg_u32 s40, 0
    s_cbranch_scc1 L_pw_A_16
    v_mul_u32_u24 v12, 3072, v1
    s_and_b32 s49, s43, 7
    s_lshl_b32 s49, s49, 4
    s_add_u32 s49, s49, 0
    s_mul_i32 s49, s49, 3072
    s_lshl_b32 s3, s45, 7
    s_add_u32 s49, s49, s3
    s_mov_b64 exec, 0xffff
    buffer_load_dword v41, v12, s[8:11], s49 offen
    s_mov_b64 exec, -1
L_pw_A_16:
    v_mul_f32 v92, v92, v84
    v_mul_f32 v93, v93, v85
    v_mul_f32 v94, v94, v86
    v_mul_f32 v95, v95, v87
    v_fma_f32 v16, v16, v7, v7
    v_fma_f32 v17, v17, v7, v7
    v_fma_f32 v18, v18, v7, v7
    ds_read_b64_tr_b16 v[48:49], v26 offset:49152
    ds_read_b64_tr_b16 v[50:51], v26 offset:49664
    s_waitcnt lgkmcnt(4)
    v_mfma_f32_32x32x16_bf16 v[96:111], v[56:59], v[180:183], v[96:111]
    s_add_u32 m0, s67, 81920
    s_add_u32 s77, s58, 327680
    v_fma_f32 v19, v19, v7, v7
    v_rcp_f32 v16, v16
    v_rcp_f32 v17, v17
    v_rcp_f32 v18, v18
    ds_read_b64_tr_b16 v[52:53], v30 offset:49152
    ds_read_b64_tr_b16 v[54:55], v30 offset:49664
    s_waitcnt lgkmcnt(4)
    v_mfma_f32_32x32x16_bf16 v[112:127], v[60:63], v[180:183], v[112:127]
    buffer_load_dwordx4 v5, s[20:23], s77 offen lds
    v_rcp_f32 v19, v19
    v_mul_f32 v84, v92, v16
    v_mul_f32 v85, v93, v17
    v_mul_f32 v86, v94, v18
    v_mul_f32 v87, v95, v19
    v_cvt_pk_bf16_f32 v80, v80, v81
    ds_read_b64_tr_b16 v[56:57], v27 offset:49152
    ds_read_b64_tr_b16 v[58:59], v27 offset:49664
    s_waitcnt lgkmcnt(4)
    v_mfma_f32_32x32x16_bf16 v[96:111], v[48:51], v[184:187], v[96:111]
    s_add_u32 s77, s58, 334848
    buffer_load_dwordx4 v5, s[20:23], s77 offen offset:1024 lds
    v_cvt_pk_bf16_f32 v81, v82, v83
    v_cvt_pk_bf16_f32 v82, v84, v85
    v_cvt_pk_bf16_f32 v83, v86, v87
    s_lshr_b32 s54, s60, 4
    s_mul_i32 s55, s42, 2
    s_add_u32 s54, s54, s55
    s_add_u32 s54, s54, 1
    s_lshl_b32 s54, s54, 10
    s_add_u32 s54, s54, s50
    buffer_store_dwordx4 v[80:83], v2, s[32:35], s54 offen sc1
    ds_read_b64_tr_b16 v[60:61], v31 offset:49152
    ds_read_b64_tr_b16 v[62:63], v31 offset:49664
    s_waitcnt lgkmcnt(4)
    v_mfma_f32_32x32x16_bf16 v[112:127], v[52:55], v[184:187], v[112:127]
    s_waitcnt vmcnt(6)
    s_barrier
    ds_read_b64_tr_b16 v[48:49], v24 offset:0
    ds_read_b64_tr_b16 v[50:51], v24 offset:512
    s_waitcnt lgkmcnt(4)
    v_mfma_f32_32x32x16_bf16 v[96:111], v[56:59], v[188:191], v[96:111]
    s_add_u32 m0, s63, 32768
    s_add_u32 s77, s48, 1376256
    ds_read_b64_tr_b16 v[52:53], v28 offset:0
    ds_read_b64_tr_b16 v[54:55], v28 offset:512
    s_waitcnt lgkmcnt(4)
    v_mfma_f32_32x32x16_bf16 v[112:127], v[60:63], v[188:191], v[112:127]
    buffer_load_dwordx4 v3, s[12:15], s77 offen lds
    ds_read_b64_tr_b16 v[56:57], v25 offset:0
    ds_read_b64_tr_b16 v[58:59], v25 offset:512
    s_waitcnt lgkmcnt(4)
    v_mfma_f32_16x16x32_bf16 v[40:43], v[36:39], v[48:51], v[40:43]
    v_mfma_f32_32x32x16_bf16 v[96:111], v[48:51], v[192:195], v[96:111]
    buffer_load_dwordx4 v4, s[16:19], s77 offen offset:1024 lds
    ds_read_b64_tr_b16 v[60:61], v29 offset:0
    ds_read_b64_tr_b16 v[62:63], v29 offset:512
    s_waitcnt lgkmcnt(4)
    v_mfma_f32_16x16x32_bf16 v[44:47], v[36:39], v[52:55], v[44:47]
    v_mfma_f32_32x32x16_bf16 v[112:127], v[52:55], v[192:195], v[112:127]
    s_cmp_lg_u32 s40, 1
    s_cbranch_scc1 L_pw_A_17
    v_mul_u32_u24 v12, 3072, v1
    s_and_b32 s49, s43, 7
    s_lshl_b32 s49, s49, 4
    s_add_u32 s49, s49, 128
    s_mul_i32 s49, s49, 3072
    s_lshl_b32 s3, s45, 7
    s_add_u32 s49, s49, s3
    s_mov_b64 exec, 0xffff
    buffer_load_dword v41, v12, s[8:11], s49 offen
    s_mov_b64 exec, -1
L_pw_A_17:
    ds_read_b64_tr_b16 v[48:49], v26 offset:0
    ds_read_b64_tr_b16 v[50:51], v26 offset:512
    s_waitcnt lgkmcnt(4)
    s_nop 0
    v_mfma_f32_32x32x16_bf16 v[96:111], v[56:59], v[196:199], v[96:111]
    ds_read_b64_tr_b16 v[52:53], v30 offset:0
    ds_read_b64_tr_b16 v[54:55], v30 offset:512
    s_waitcnt lgkmcnt(4)
    v_mfma_f32_32x32x16_bf16 v[112:127], v[60:63], v[196:199], v[112:127]
    ds_read_b64_tr_b16 v[56:57], v27 offset:0
    ds_read_b64_tr_b16 v[58:59], v27 offset:512
    s_waitcnt lgkmcnt(4)
    v_mfma_f32_32x32x16_bf16 v[96:111], v[48:51], v[200:203], v[96:111]
    ds_read_b64_tr_b16 v[60:61], v31 offset:0
    ds_read_b64_tr_b16 v[62:63], v31 offset:512
    s_waitcnt lgkmcnt(4)
    v_mfma_f32_32x32x16_bf16 v[112:127], v[52:55], v[200:203], v[112:127]
    s_waitcnt vmcnt(5)
    s_barrier
    ds_read_b64_tr_b16 v[48:49], v24 offset:16384
    ds_read_b64_tr_b16 v[50:51], v24 offset:16896
    s_waitcnt lgkmcnt(4)
    v_mfma_f32_32x32x16_bf16 v[96:111], v[56:59], v[204:207], v[96:111]
    s_add_u32 m0, s63, 49152
    s_add_u32 s77, s48, 1605632
    ds_read_b64_tr_b16 v[52:53], v28 offset:16384
    ds_read_b64_tr_b16 v[54:55], v28 offset:16896
    s_waitcnt lgkmcnt(4)
    v_mfma_f32_32x32x16_bf16 v[112:127], v[60:63], v[204:207], v[112:127]
    buffer_load_dwordx4 v3, s[12:15], s77 offen lds
    ds_read_b64_tr_b16 v[56:57], v25 offset:16384
    ds_read_b64_tr_b16 v[58:59], v25 offset:16896
    s_waitcnt lgkmcnt(4)
    v_mfma_f32_16x16x32_bf16 v[40:43], v[36:39], v[48:51], v[40:43]
    v_mfma_f32_32x32x16_bf16 v[96:111], v[48:51], v[208:211], v[96:111]
    buffer_load_dwordx4 v4, s[16:19], s77 offen offset:1024 lds
    ds_read_b64_tr_b16 v[60:61], v29 offset:16384
    ds_read_b64_tr_b16 v[62:63], v29 offset:16896
    s_waitcnt lgkmcnt(4)
    v_mfma_f32_16x16x32_bf16 v[44:47], v[36:39], v[52:55], v[44:47]
    v_mfma_f32_32x32x16_bf16 v[112:127], v[52:55], v[208:211], v[112:127]
    s_cmp_lg_u32 s40, 2
    s_cbranch_scc1 L_pw_A_18
    v_mul_u32_u24 v12, 3072, v1
    s_and_b32 s49, s43, 7
    s_lshl_b32 s49, s49, 4
    s_add_u32 s49, s49, 256
    s_mul_i32 s49, s49, 3072
    s_lshl_b32 s3, s45, 7
    s_add_u32 s49, s49, s3
    s_mov_b64 exec, 0xffff
    buffer_load_dword v41, v12, s[8:11], s49 offen
    s_mov_b64 exec, -1
L_pw_A_18:
    ds_read_b64_tr_b16 v[48:49], v26 offset:16384
    ds_read_b64_tr_b16 v[50:51], v26 offset:16896
    s_waitcnt lgkmcnt(4)
    s_nop 0
    v_mfma_f32_32x32x16_bf16 v[96:111], v[56:59], v[212:215], v[96:111]
    s_add_u32 m0, s67, 98304
    s_add_u32 s77, s58, 360448
    ds_read_b64_tr_b16 v[52:53], v30 offset:16384
    ds_read_b64_tr_b16 v[54:55], v30 offset:16896
    s_waitcnt lgkmcnt(4)
    v_mfma_f32_32x32x16_bf16 v[112:127], v[60:63], v[212:215], v[112:127]
    buffer_load_dwordx4 v5, s[20:23], s77 offen lds
    ds_read_b64_tr_b16 v[56:57], v27 offset:16384
    ds_read_b64_tr_b16 v[58:59], v27 offset:16896
    s_waitcnt lgkmcnt(4)
    v_mfma_f32_32x32x16_bf16 v[96:111], v[48:51], v[216:219], v[96:111]
    s_add_u32 s77, s58, 367616
    buffer_load_dwordx4 v5, s[20:23], s77 offen offset:1024 lds
    ds_read_b64_tr_b16 v[60:61], v31 offset:16384
    ds_read_b64_tr_b16 v[62:63], v31 offset:16896
    s_waitcnt lgkmcnt(4)
    v_mfma_f32_32x32x16_bf16 v[112:127], v[52:55], v[216:219], v[112:127]
    s_waitcnt vmcnt(4)
    s_barrier
    ds_read_b64_tr_b16 v[48:49], v24 offset:32768
    ds_read_b64_tr_b16 v[50:51], v24 offset:33280
    s_waitcnt lgkmcnt(4)
    v_mfma_f32_32x32x16_bf16 v[96:111], v[56:59], v[220:223], v[96:111]
    v_lshrrev_b32 v3, 3, v1
    v_lshrrev_b32 v9, 2, v1
    v_and_b32 v9, 3, v9
    v_and_b32 v13, 3, v1
    v_lshlrev_b32 v13, 3, v13
    v_lshrrev_b32 v10, 4, v1
    v_and_b32 v10, 1, v10
    v_lshrrev_b32 v11, 5, v1
    ds_read_b64_tr_b16 v[52:53], v28 offset:32768
    ds_read_b64_tr_b16 v[54:55], v28 offset:33280
    s_waitcnt lgkmcnt(4)
    v_mfma_f32_32x32x16_bf16 v[112:127], v[60:63], v[220:223], v[112:127]
    v_and_b32 v4, 7, v1
    v_lshlrev_b32 v11, 10, v11
    v_add_u32 v13, v13, v11
    v_lshlrev_b32 v11, 5, v10
    v_add_u32 v13, v13, v11
    v_lshlrev_b32 v11, 7, v9
    v_add_u32 v13, v13, v11
    v_lshrrev_b32 v9, 1, v9
    ds_read_b64_tr_b16 v[56:57], v25 offset:32768
    ds_read_b64_tr_b16 v[58:59], v25 offset:33280
    s_waitcnt lgkmcnt(4)
    v_mfma_f32_16x16x32_bf16 v[40:43], v[36:39], v[48:51], v[40:43]
    v_mfma_f32_32x32x16_bf16 v[96:111], v[48:51], v[224:227], v[96:111]
    v_and_b32 v12, 2, v3
    v_xor_b32 v9, s42, v9
    v_lshlrev_b32 v9, 6, v9
    v_add_u32 v13, v13, v9
    s_lshl_b32 s55, s46, 11
    v_add_u32 v13, s55, v13
    ds_read_b64_tr_b16 v[60:61], v29 offset:32768
    ds_read_b64_tr_b16 v[62:63], v29 offset:33280
    s_waitcnt lgkmcnt(4)
    v_mfma_f32_16x16x32_bf16 v[44:47], v[36:39], v[52:55], v[44:47]
    v_mfma_f32_32x32x16_bf16 v[112:127], v[52:55], v[224:227], v[112:127]
    v_lshlrev_b32 v12, 1, v12
    ds_read_b64_tr_b16 v[48:49], v26 offset:32768
    ds_read_b64_tr_b16 v[50:51], v26 offset:33280
    s_waitcnt lgkmcnt(4)
    v_mfma_f32_32x32x16_bf16 v[96:111], v[56:59], v[228:231], v[96:111]
    v_xor_b32 v4, v4, v12
    ds_read_b64_tr_b16 v[52:53], v30 offset:32768
    ds_read_b64_tr_b16 v[54:55], v30 offset:33280
    s_waitcnt lgkmcnt(4)
    v_mfma_f32_32x32x16_bf16 v[112:127], v[60:63], v[228:231], v[112:127]
    v_lshlrev_b32 v4, 4, v4
    ds_read_b64_tr_b16 v[56:57], v27 offset:32768
    ds_read_b64_tr_b16 v[58:59], v27 offset:33280
    s_waitcnt lgkmcnt(4)
    v_mfma_f32_32x32x16_bf16 v[96:111], v[48:51], v[232:235], v[96:111]
    v_mul_u32_u24 v3, 3072, v3
    ds_read_b64_tr_b16 v[60:61], v31 offset:32768
    ds_read_b64_tr_b16 v[62:63], v31 offset:33280
    s_waitcnt lgkmcnt(4)
    v_mfma_f32_32x32x16_bf16 v[112:127], v[52:55], v[232:235], v[112:127]
    v_add_u32 v3, v3, v4
    s_mul_i32 s48, s40, 49152
    s_lshl_b32 s77, s45, 7
    s_add_u32 s48, s48, s77
    s_add_u32 m0, s63, 0
    s_add_u32 s77, s48, 0
    buffer_load_dwordx4 v3, s[8:11], s77 offen lds
    s_add_u32 s77, s48, 23552
    buffer_load_dwordx4 v3, s[8:11], s77 offen offset:1024 lds
    s_cmp_lg_u32 s40, 3
    s_cbranch_scc1 L_pw_A_19
    v_mul_u32_u24 v12, 3072, v1
    s_and_b32 s49, s43, 7
    s_lshl_b32 s49, s49, 4
    s_add_u32 s49, s49, 384
    s_mul_i32 s49, s49, 3072
    s_lshl_b32 s3, s45, 7
    s_add_u32 s49, s49, s3
    s_mov_b64 exec, 0xffff
    buffer_load_dword v41, v12, s[8:11], s49 offen
    s_mov_b64 exec, -1
L_pw_A_19:
    s_waitcnt vmcnt(4)
    s_barrier
    ds_read_b64_tr_b16 v[48:49], v24 offset:49152
    ds_read_b64_tr_b16 v[50:51], v24 offset:49664
    v_xor_b32 v24, 0, v13
    s_waitcnt lgkmcnt(4)
    v_mfma_f32_32x32x16_bf16 v[96:111], v[56:59], v[236:239], v[96:111]
    s_add_u32 m0, s63, 16384
    s_add_u32 s77, s48, 393216
    s_cmp_lg_u32 s40, 0
    s_cbranch_scc1 L_fl_f1aA
    s_lshl_b32 s54, s43, 7
    s_lshl_b32 s55, s44, 2
    s_add_u32 s54, s54, s55
    s_add_u32 s54, s54, 12582912
    v_mov_b32 v9, s51
    v_mov_b32 v10, 0
    s_mov_b64 s[68:69], exec
    s_mov_b64 exec, 1
    buffer_store_dword v9, v10, s[32:35], s54 offen sc1
    s_mov_b64 exec, s[68:69]
L_fl_f1aA:
    ds_read_b64_tr_b16 v[52:53], v28 offset:49152
    ds_read_b64_tr_b16 v[54:55], v28 offset:49664
    s_waitcnt lgkmcnt(4)
    s_nop 0
    v_mfma_f32_32x32x16_bf16 v[112:127], v[60:63], v[236:239], v[112:127]
    buffer_load_dwordx4 v3, s[8:11], s77 offen lds
    ds_read_b64_tr_b16 v[56:57], v25 offset:49152
    ds_read_b64_tr_b16 v[58:59], v25 offset:49664
    v_xor_b32 v25, 2048, v13
    s_waitcnt lgkmcnt(4)
    v_mfma_f32_16x16x32_bf16 v[40:43], v[36:39], v[48:51], v[40:43]
    v_mfma_f32_32x32x16_bf16 v[96:111], v[48:51], v[240:243], v[96:111]
    s_add_u32 s77, s48, 416768
    buffer_load_dwordx4 v3, s[8:11], s77 offen offset:1024 lds
    ds_read_b64_tr_b16 v[60:61], v29 offset:49152
    ds_read_b64_tr_b16 v[62:63], v29 offset:49664
    s_waitcnt lgkmcnt(4)
    v_mfma_f32_16x16x32_bf16 v[44:47], v[36:39], v[52:55], v[44:47]
    v_mfma_f32_32x32x16_bf16 v[112:127], v[52:55], v[240:243], v[112:127]
    ds_write_b32 v15, v40 offset:0
    s_nop 5
    ds_write_b32 v15, v44 offset:512
    ds_read_b64_tr_b16 v[48:49], v26 offset:49152
    ds_read_b64_tr_b16 v[50:51], v26 offset:49664
    v_xor_b32 v26, 4096, v13
    s_waitcnt lgkmcnt(6)
    v_mfma_f32_32x32x16_bf16 v[96:111], v[56:59], v[244:247], v[96:111]
    ds_read_b64_tr_b16 v[52:53], v30 offset:49152
    ds_read_b64_tr_b16 v[54:55], v30 offset:49664
    s_waitcnt lgkmcnt(6)
    v_mfma_f32_32x32x16_bf16 v[112:127], v[60:63], v[244:247], v[112:127]
    ds_read_b64_tr_b16 v[56:57], v27 offset:49152
    ds_read_b64_tr_b16 v[58:59], v27 offset:49664
    v_xor_b32 v27, 6144, v13
    s_waitcnt lgkmcnt(4)
    v_mfma_f32_32x32x16_bf16 v[96:111], v[48:51], v[248:251], v[96:111]
    ds_read_b64_tr_b16 v[60:61], v31 offset:49152
    ds_read_b64_tr_b16 v[62:63], v31 offset:49664
    s_waitcnt lgkmcnt(4)
    v_mfma_f32_32x32x16_bf16 v[112:127], v[52:55], v[248:251], v[112:127]
    s_waitcnt vmcnt(2)
    s_waitcnt lgkmcnt(0)
    s_barrier
    ds_read_b64_tr_b16 v[48:49], v24 offset:0
    ds_read_b64_tr_b16 v[50:51], v24 offset:512
    v_mfma_f32_32x32x16_bf16 v[96:111], v[56:59], v[252:255], v[96:111]
    s_add_u32 m0, s63, 32768
    s_add_u32 s77, s48, 786432
    ds_read_b128 v[16:19], v14 offset:0
    s_waitcnt lgkmcnt(0)
    v_add_f32 v16, v16, v17
    v_add_f32 v18, v18, v19
    v_mov_b32 v22, 0
    v_add_f32 v16, v16, v18
    v_mov_b32 v23, 0
    v_cvt_pk_bf16_f32 v20, v16, v16
    ds_read_b64_tr_b16 v[52:53], v25 offset:0
    ds_read_b64_tr_b16 v[54:55], v25 offset:512
    v_mfma_f32_32x32x16_bf16 v[112:127], v[60:63], v[252:255], v[112:127]
    buffer_load_dwordx4 v3, s[8:11], s77 offen lds
    v_and_b32 v17, 0xffff0000, v20
    v_sub_f32 v16, v16, v17
    v_cvt_pk_bf16_f32 v21, v16, 0
    s_nop 1
    v_mfma_f32_32x32x16_bf16 v[96:111], v[20:23], v[32:35], v[96:111]
    ds_read_b64_tr_b16 v[56:57], v26 offset:0
    ds_read_b64_tr_b16 v[58:59], v26 offset:512
    v_mfma_f32_16x16x32_bf16 v[40:43], v[36:39], v[48:51], 0
    v_mfma_f32_32x32x16_bf16 v[64:79], v[48:51], v[128:131], 0
    s_add_u32 s77, s48, 809984
    buffer_load_dwordx4 v3, s[8:11], s77 offen offset:1024 lds
    ds_read_b128 v[16:19], v14 offset:512
    s_waitcnt lgkmcnt(0)
    v_add_f32 v16, v16, v17
    v_add_f32 v18, v18, v19
    v_mov_b32 v22, 0
    v_add_f32 v16, v16, v18
    v_mov_b32 v23, 0
    ds_read_b64_tr_b16 v[60:61], v27 offset:0
    ds_read_b64_tr_b16 v[62:63], v27 offset:512
    v_mfma_f32_32x32x16_bf16 v[64:79], v[52:55], v[132:135], v[64:79]
    v_cvt_pk_bf16_f32 v20, v16, v16
    v_and_b32 v17, 0xffff0000, v20
    v_sub_f32 v16, v16, v17
    v_cvt_pk_bf16_f32 v21, v16, 0
    s_nop 1
    v_mfma_f32_32x32x16_bf16 v[112:127], v[20:23], v[32:35], v[112:127]
    ds_read_b64_tr_b16 v[48:49], v24 offset:8192
    ds_read_b64_tr_b16 v[50:51], v24 offset:8704
    v_mfma_f32_32x32x16_bf16 v[64:79], v[56:59], v[136:139], v[64:79]
    v_mul_f32 v96, v6, v96
    v_mul_f32 v97, v6, v97
    v_mul_f32 v98, v6, v98
    v_mul_f32 v99, v6, v99
    v_exp_f32 v16, v96
    ds_read_b64_tr_b16 v[52:53], v25 offset:8192
    ds_read_b64_tr_b16 v[54:55], v25 offset:8704
    s_waitcnt lgkmcnt(4)
    v_mfma_f32_32x32x16_bf16 v[64:79], v[60:63], v[140:143], v[64:79]
    v_exp_f32 v17, v97
    v_exp_f32 v18, v98
    v_exp_f32 v19, v99
    ds_read_b64_tr_b16 v[56:57], v26 offset:8192
    ds_read_b64_tr_b16 v[58:59], v26 offset:8704
    s_waitcnt lgkmcnt(4)
    v_mfma_f32_16x16x32_bf16 v[40:43], v[36:39], v[48:51], v[40:43]
    v_mfma_f32_32x32x16_bf16 v[64:79], v[48:51], v[144:147], v[64:79]
    v_mul_f32 v104, v104, v96
    v_mul_f32 v105, v105, v97
    v_mul_f32 v106, v106, v98
    v_mul_f32 v107, v107, v99
    v_fma_f32 v16, v16, v7, v7
    v_fma_f32 v17, v17, v7, v7
    ds_read_b64_tr_b16 v[60:61], v27 offset:8192
    ds_read_b64_tr_b16 v[62:63], v27 offset:8704
    s_waitcnt lgkmcnt(4)
    v_mfma_f32_32x32x16_bf16 v[64:79], v[52:55], v[148:151], v[64:79]
    s_waitcnt vmcnt(2)
    s_barrier
    ds_read_b64_tr_b16 v[48:49], v24 offset:16384
    ds_read_b64_tr_b16 v[50:51], v24 offset:16896
    s_waitcnt lgkmcnt(4)
    v_mfma_f32_32x32x16_bf16 v[64:79], v[56:59], v[152:155], v[64:79]
    s_add_u32 m0, s63, 49152
    s_add_u32 s77, s48, 1179648
    v_fma_f32 v18, v18, v7, v7
    v_fma_f32 v19, v19, v7, v7
    v_rcp_f32 v16, v16
    v_rcp_f32 v17, v17
    ds_read_b64_tr_b16 v[52:53], v25 offset:16384
    ds_read_b64_tr_b16 v[54:55], v25 offset:16896
    s_waitcnt lgkmcnt(4)
    v_mfma_f32_32x32x16_bf16 v[64:79], v[60:63], v[156:159], v[64:79]
    buffer_load_dwordx4 v3, s[8:11], s77 offen lds
    v_rcp_f32 v18, v18
    v_rcp_f32 v19, v19
    v_mul_f32 v96, v104, v16
    v_mul_f32 v97, v105, v17
    ds_read_b64_tr_b16 v[56:57], v26 offset:16384
    ds_read_b64_tr_b16 v[58:59], v26 offset:16896
    s_waitcnt lgkmcnt(4)
    v_mfma_f32_16x16x32_bf16 v[40:43], v[36:39], v[48:51], v[40:43]
    v_mfma_f32_32x32x16_bf16 v[64:79], v[48:51], v[160:163], v[64:79]
    s_add_u32 s77, s48, 1203200
    buffer_load_dwordx4 v3, s[8:11], s77 offen offset:1024 lds
    v_mul_f32 v98, v106, v18
    v_mul_f32 v99, v107, v19
    v_mul_f32 v100, v6, v100
    v_mul_f32 v101, v6, v101
    v_mul_f32 v102, v6, v102
    v_mul_f32 v103, v6, v103
    ds_read_b64_tr_b16 v[60:61], v27 offset:16384
    ds_read_b64_tr_b16 v[62:63], v27 offset:16896
    s_waitcnt lgkmcnt(4)
    v_mfma_f32_32x32x16_bf16 v[64:79], v[52:55], v[164:167], v[64:79]
    s_add_u32 m0, s67, 114688
    s_add_u32 s77, s58, 65536
    v_exp_f32 v16, v100
    v_exp_f32 v17, v101
    v_exp_f32 v18, v102
    ds_read_b64_tr_b16 v[48:49], v24 offset:24576
    ds_read_b64_tr_b16 v[50:51], v24 offset:25088
    s_waitcnt lgkmcnt(4)
    v_mfma_f32_32x32x16_bf16 v[64:79], v[56:59], v[168:171], v[64:79]
    buffer_load_dwordx4 v5, s[20:23], s77 offen lds
    v_exp_f32 v19, v103
    v_mul_f32 v108, v108, v100
    v_mul_f32 v109, v109, v101
    v_mul_f32 v110, v110, v102
    v_mul_f32 v111, v111, v103
    ds_read_b64_tr_b16 v[52:53], v25 offset:24576
    ds_read_b64_tr_b16 v[54:55], v25 offset:25088
    s_waitcnt lgkmcnt(4)
    v_mfma_f32_32x32x16_bf16 v[64:79], v[60:63], v[172:175], v[64:79]
    s_add_u32 s77, s58, 72704
    buffer_load_dwordx4 v5, s[20:23], s77 offen offset:1024 lds
    v_fma_f32 v16, v16, v7, v7
    v_fma_f32 v17, v17, v7, v7
    v_fma_f32 v18, v18, v7, v7
    v_fma_f32 v19, v19, v7, v7
    v_rcp_f32 v16, v16
    ds_read_b64_tr_b16 v[56:57], v26 offset:24576
    ds_read_b64_tr_b16 v[58:59], v26 offset:25088
    s_waitcnt lgkmcnt(4)
    v_mfma_f32_16x16x32_bf16 v[40:43], v[36:39], v[48:51], v[40:43]
    v_mfma_f32_32x32x16_bf16 v[64:79], v[48:51], v[176:179], v[64:79]
    v_rcp_f32 v17, v17
    v_rcp_f32 v18, v18
    v_rcp_f32 v19, v19
    ds_read_b64_tr_b16 v[60:61], v27 offset:24576
    ds_read_b64_tr_b16 v[62:63], v27 offset:25088
    s_waitcnt lgkmcnt(4)
    v_mfma_f32_32x32x16_bf16 v[64:79], v[52:55], v[180:183], v[64:79]
    s_waitcnt vmcnt(4)
    s_barrier
    ds_read_b64_tr_b16 v[48:49], v24 offset:32768
    ds_read_b64_tr_b16 v[50:51], v24 offset:33280
    s_waitcnt lgkmcnt(4)
    v_mfma_f32_32x32x16_bf16 v[64:79], v[56:59], v[184:187], v[64:79]
    v_mul_f32 v100, v108, v16
    v_mul_f32 v101, v109, v17
    v_mul_f32 v102, v110, v18
    v_mul_f32 v103, v111, v19
    v_cvt_pk_bf16_f32 v96, v96, v97
    v_cvt_pk_bf16_f32 v97, v98, v99
    ds_read_b64_tr_b16 v[52:53], v25 offset:32768
    ds_read_b64_tr_b16 v[54:55], v25 offset:33280
    s_waitcnt lgkmcnt(4)
    v_mfma_f32_32x32x16_bf16 v[64:79], v[60:63], v[188:191], v[64:79]
    v_cvt_pk_bf16_f32 v98, v100, v101
    v_cvt_pk_bf16_f32 v99, v102, v103
    s_lshr_b32 s54, s61, 4
    s_mul_i32 s55, s42, 2
    s_add_u32 s54, s54, s55
    s_add_u32 s54, s54, 0
    s_lshl_b32 s54, s54, 10
    s_add_u32 s54, s54, s50
    buffer_store_dwordx4 v[96:99], v2, s[32:35], s54 offen sc1
    ds_read_b64_tr_b16 v[56:57], v26 offset:32768
    ds_read_b64_tr_b16 v[58:59], v26 offset:33280
    s_waitcnt lgkmcnt(4)
    v_mfma_f32_16x16x32_bf16 v[40:43], v[36:39], v[48:51], v[40:43]
    v_mfma_f32_32x32x16_bf16 v[64:79], v[48:51], v[192:195], v[64:79]
    v_mul_f32 v112, v6, v112
    v_mul_f32 v113, v6, v113
    v_mul_f32 v114, v6, v114
    v_mul_f32 v115, v6, v115
    v_exp_f32 v16, v112
    ds_read_b64_tr_b16 v[60:61], v27 offset:32768
    ds_read_b64_tr_b16 v[62:63], v27 offset:33280
    s_waitcnt lgkmcnt(4)
    v_mfma_f32_32x32x16_bf16 v[64:79], v[52:55], v[196:199], v[64:79]
    v_exp_f32 v17, v113
    v_exp_f32 v18, v114
    v_exp_f32 v19, v115
    ds_read_b64_tr_b16 v[48:49], v24 offset:40960
    ds_read_b64_tr_b16 v[50:51], v24 offset:41472
    s_waitcnt lgkmcnt(4)
    v_mfma_f32_32x32x16_bf16 v[64:79], v[56:59], v[200:203], v[64:79]
    v_mul_f32 v120, v120, v112
    v_mul_f32 v121, v121, v113
    v_mul_f32 v122, v122, v114
    v_mul_f32 v123, v123, v115
    v_fma_f32 v16, v16, v7, v7
    v_fma_f32 v17, v17, v7, v7
    ds_read_b64_tr_b16 v[52:53], v25 offset:40960
    ds_read_b64_tr_b16 v[54:55], v25 offset:41472
    s_waitcnt lgkmcnt(4)
    v_mfma_f32_32x32x16_bf16 v[64:79], v[60:63], v[204:207], v[64:79]
    v_fma_f32 v18, v18, v7, v7
    v_fma_f32 v19, v19, v7, v7
    v_rcp_f32 v16, v16
    v_rcp_f32 v17, v17
    ds_read_b64_tr_b16 v[56:57], v26 offset:40960
    ds_read_b64_tr_b16 v[58:59], v26 offset:41472
    s_waitcnt lgkmcnt(4)
    v_mfma_f32_16x16x32_bf16 v[40:43], v[36:39], v[48:51], v[40:43]
    v_mfma_f32_32x32x16_bf16 v[64:79], v[48:51], v[208:211], v[64:79]
    v_rcp_f32 v18, v18
    v_rcp_f32 v19, v19
    v_mul_f32 v112, v120, v16
    v_mul_f32 v113, v121, v17
    ds_read_b64_tr_b16 v[60:61], v27 offset:40960
    ds_read_b64_tr_b16 v[62:63], v27 offset:41472
    s_waitcnt lgkmcnt(4)
    v_mfma_f32_32x32x16_bf16 v[64:79], v[52:55], v[212:215], v[64:79]
    v_mul_f32 v114, v122, v18
    v_mul_f32 v115, v123, v19
    v_mul_f32 v116, v6, v116
    v_mul_f32 v117, v6, v117
    v_mul_f32 v118, v6, v118
    v_mul_f32 v119, v6, v119
    v_exp_f32 v16, v116
    v_exp_f32 v17, v117
    v_exp_f32 v18, v118
    v_exp_f32 v19, v119
    v_mul_f32 v124, v124, v116
    v_mul_f32 v125, v125, v117
    v_mul_f32 v126, v126, v118
    v_mul_f32 v127, v127, v119
    v_fma_f32 v16, v16, v7, v7
    v_fma_f32 v17, v17, v7, v7
    v_fma_f32 v18, v18, v7, v7
    v_fma_f32 v19, v19, v7, v7
    v_rcp_f32 v16, v16
    v_rcp_f32 v17, v17
    v_rcp_f32 v18, v18
    v_rcp_f32 v19, v19
    v_mul_f32 v116, v124, v16
    v_mul_f32 v117, v125, v17
    v_mul_f32 v118, v126, v18
    v_mul_f32 v119, v127, v19
    v_cvt_pk_bf16_f32 v112, v112, v113
    v_cvt_pk_bf16_f32 v113, v114, v115
    v_cvt_pk_bf16_f32 v114, v116, v117
    v_cvt_pk_bf16_f32 v115, v118, v119
    s_lshr_b32 s54, s61, 4
    s_mul_i32 s55, s42, 2
    s_add_u32 s54, s54, s55
    s_add_u32 s54, s54, 1
    s_lshl_b32 s54, s54, 10
    s_add_u32 s54, s54, s50
    buffer_store_dwordx4 v[112:115], v2, s[32:35], s54 offen sc1
    s_cmp_lg_u32 s40, 3
    s_cbranch_scc1 L_r1_A
    v_and_b32 v9, 15, v1
    v_lshlrev_b32 v9, 2, v9
    s_lshr_b32 s54, s70, 2
    s_lshl_b32 s54, s54, 7
    s_add_u32 s54, s54, 12587008
    buffer_load_dword v80, v9, s[32:35], s54 offen sc1
L_r1_A:
    s_waitcnt vmcnt(4)
    s_barrier
    ds_read_b64_tr_b16 v[48:49], v24 offset:49152
    ds_read_b64_tr_b16 v[50:51], v24 offset:49664
    s_waitcnt lgkmcnt(4)
    v_mfma_f32_32x32x16_bf16 v[64:79], v[56:59], v[216:219], v[64:79]
    v_and_b32 v9, 7, v1
    v_lshlrev_b32 v9, 3, v9
    s_lshr_b32 s54, s64, 1
    s_lshl_b32 s54, s54, 7
    s_add_u32 s54, s54, 12582912
    buffer_load_dword v95, v9, s[32:35], s54 offen sc1
    ds_read_b64_tr_b16 v[52:53], v25 offset:49152
    ds_read_b64_tr_b16 v[54:55], v25 offset:49664
    s_waitcnt lgkmcnt(4)
    v_mfma_f32_32x32x16_bf16 v[64:79], v[60:63], v[220:223], v[64:79]
    ds_read_b64_tr_b16 v[56:57], v26 offset:49152
    ds_read_b64_tr_b16 v[58:59], v26 offset:49664
    s_waitcnt lgkmcnt(4)
    v_mfma_f32_16x16x32_bf16 v[40:43], v[36:39], v[48:51], v[40:43]
    v_mfma_f32_32x32x16_bf16 v[64:79], v[48:51], v[224:227], v[64:79]
    ds_read_b64_tr_b16 v[60:61], v27 offset:49152
    ds_read_b64_tr_b16 v[62:63], v27 offset:49664
    s_waitcnt lgkmcnt(4)
    v_mfma_f32_32x32x16_bf16 v[64:79], v[52:55], v[228:231], v[64:79]
    ds_read_b64_tr_b16 v[48:49], v24 offset:57344
    ds_read_b64_tr_b16 v[50:51], v24 offset:57856
    s_waitcnt lgkmcnt(4)
    v_mfma_f32_32x32x16_bf16 v[64:79], v[56:59], v[232:235], v[64:79]
    ds_read_b64_tr_b16 v[52:53], v25 offset:57344
    ds_read_b64_tr_b16 v[54:55], v25 offset:57856
    s_waitcnt lgkmcnt(4)
    v_mfma_f32_32x32x16_bf16 v[64:79], v[60:63], v[236:239], v[64:79]
    ds_read_b64_tr_b16 v[56:57], v26 offset:57344
    ds_read_b64_tr_b16 v[58:59], v26 offset:57856
    s_waitcnt lgkmcnt(4)
    v_mfma_f32_16x16x32_bf16 v[40:43], v[36:39], v[48:51], v[40:43]
    v_mfma_f32_32x32x16_bf16 v[64:79], v[48:51], v[240:243], v[64:79]
    s_nop 6
    ds_write_b32 v15, v40 offset:0
    ds_read_b64_tr_b16 v[60:61], v27 offset:57344
    ds_read_b64_tr_b16 v[62:63], v27 offset:57856
    s_waitcnt lgkmcnt(5)
    v_mfma_f32_32x32x16_bf16 v[64:79], v[52:55], v[244:247], v[64:79]
    s_waitcnt lgkmcnt(3)
    v_mfma_f32_32x32x16_bf16 v[64:79], v[56:59], v[248:251], v[64:79]
    s_waitcnt lgkmcnt(0)
    v_mfma_f32_32x32x16_bf16 v[64:79], v[60:63], v[252:255], v[64:79]
    s_waitcnt vmcnt(3)
    s_waitcnt lgkmcnt(0)
    s_barrier
    s_lshl_b32 s52, s64, 1
    s_add_u32 s52, s52, s79
    s_mul_i32 s52, s52, 147456
    s_add_u32 s52, s52, 0
    s_mul_i32 s60, s78, 28672
    s_add_u32 s60, s60, s52
    s_lshl_b32 s61, s78, 13
    s_add_u32 s61, s61, s52
    s_add_u32 s61, s61, 114688
    s_waitcnt vmcnt(0)
    v_cmp_eq_u32 vcc, s51, v95
    s_mov_b32 s72, 0
    s_nop 1
    s_cmp_eq_u64 vcc, exec
    s_cbranch_scc1 L_f1aok_A
    v_and_b32 v9, 7, v1
    v_lshlrev_b32 v9, 3, v9
    s_lshr_b32 s54, s64, 1
    s_lshl_b32 s54, s54, 7
    s_add_u32 s54, s54, 12582912
L_f1al_A:
    buffer_load_dword v95, v9, s[32:35], s54 offen sc1
    s_waitcnt vmcnt(0)
    v_cmp_eq_u32 vcc, s51, v95
    s_add_u32 s72, s72, 1
    s_cmp_gt_u32 s72, 0x80000
    s_cbranch_scc1 L_f1aok_A
    s_cmp_eq_u64 vcc, exec
    s_cbranch_scc1 L_f1aok_A
    s_sleep 4
    s_branch L_f1al_A
L_f1aok_A:
    buffer_load_dwordx4 v[208:211], v2, s[32:35], s60 offen offset:0 sc1
    buffer_load_dwordx4 v[212:215], v2, s[32:35], s60 offen offset:1024 sc1
    buffer_load_dwordx4 v[216:219], v2, s[32:35], s60 offen offset:2048 sc1
    buffer_load_dwordx4 v[220:223], v2, s[32:35], s60 offen offset:3072 sc1
    s_add_u32 s48, s60, 20480
    buffer_load_dwordx4 v[224:227], v2, s[32:35], s48 offen offset:0 sc1
    s_add_u32 s48, s60, 20480
    buffer_load_dwordx4 v[228:231], v2, s[32:35], s48 offen offset:1024 sc1
    s_add_u32 s48, s60, 20480
    buffer_load_dwordx4 v[232:235], v2, s[32:35], s48 offen offset:2048 sc1
    s_add_u32 s48, s60, 20480
    buffer_load_dwordx4 v[236:239], v2, s[32:35], s48 offen offset:3072 sc1
    s_cmp_lg_u32 s40, 3
    s_cbranch_scc1 L_r2_A
    v_cmp_eq_u32 vcc, s51, v80
    s_mov_b32 s72, 0
    v_and_b32 v9, 15, v1
    v_lshlrev_b32 v9, 2, v9
    s_lshr_b32 s54, s70, 2
    s_lshl_b32 s54, s54, 7
    s_add_u32 s54, s54, 12587008
    s_cmp_eq_u64 vcc, exec
    s_cbranch_scc1 L_rok_A
L_rpoll_A:
    buffer_load_dword v80, v9, s[32:35], s54 offen sc1
    s_waitcnt vmcnt(0)
    v_cmp_eq_u32 vcc, s51, v80
    s_add_u32 s72, s72, 1
    s_cmp_gt_u32 s72, 0x80000
    s_cbranch_scc1 L_rok_A
    s_cmp_eq_u64 vcc, exec
    s_cbranch_scc1 L_rok_A
    s_sleep 4
    s_branch L_rpoll_A
L_rok_A:
    v_lshrrev_b32 v9, 3, v1
    v_mul_u32_u24 v9, 36864, v9
    v_and_b32 v10, 7, v1
    v_lshlrev_b32 v10, 4, v10
    v_add_u32 v9, v9, v10
    s_mul_i32 s54, s70, 1152
    s_lshl_b32 s55, s71, 7
    s_add_u32 s55, s55, s54
    s_add_u32 s55, s55, 10485760
    buffer_load_dwordx4 v[80:83], v9, s[32:35], s55 offen sc1
    s_add_u32 s55, s55, 294912
    buffer_load_dwordx4 v[84:87], v9, s[32:35], s55 offen sc1
    v_and_b32 v10, 15, v1
    v_mul_u32_u24 v10, 36864, v10
    s_lshl_b32 s55, s71, 3
    s_add_u32 s55, s55, s54
    s_add_u32 s55, s55, 10486784
    buffer_load_dwordx2 v[88:89], v10, s[32:35], s55 offen sc1
L_r2_A:
    ds_read_b128 v[16:19], v14 offset:0
    s_waitcnt lgkmcnt(0)
    v_add_f32 v16, v16, v17
    v_add_f32 v18, v18, v19
    v_mov_b32 v22, 0
    v_add_f32 v16, v16, v18
    v_mov_b32 v23, 0
    v_cvt_pk_bf16_f32 v20, v16, v16
    v_and_b32 v17, 0xffff0000, v20
    v_sub_f32 v16, v16, v17
    v_cvt_pk_bf16_f32 v21, v16, 0
    s_nop 1
    v_mfma_f32_32x32x16_bf16 v[64:79], v[20:23], v[32:35], v[64:79]
    s_nop 11
    v_min_f32 v16, 0, v64
    v_min_f32 v17, 0, v65
    v_min_f32 v18, 0, v66
    v_min_f32 v19, 0, v67
    v_mul_f32 v16, -v6, v16
    v_mul_f32 v17, -v6, v17
    v_mul_f32 v18, -v6, v18
    v_mul_f32 v19, -v6, v19
    v_exp_f32 v16, v16
    v_exp_f32 v17, v17
    v_exp_f32 v18, v18
    v_exp_f32 v19, v19
    v_max_f32 v64, 0, v64
    v_max_f32 v65, 0, v65
    v_max_f32 v66, 0, v66
    v_max_f32 v67, 0, v67
    v_fma_f32 v64, v64, v8, v16
    v_fma_f32 v65, v65, v8, v17
    v_fma_f32 v66, v66, v8, v18
    v_fma_f32 v67, v67, v8, v19
    v_add_f32 v64, 0x358637bd, v64
    v_add_f32 v65, 0x358637bd, v65
    v_add_f32 v66, 0x358637bd, v66
    v_add_f32 v67, 0x358637bd, v67
    v_min_f32 v16, 0, v68
    v_min_f32 v17, 0, v69
    v_min_f32 v18, 0, v70
    v_min_f32 v19, 0, v71
    v_mul_f32 v16, -v6, v16
    v_mul_f32 v17, -v6, v17
    v_mul_f32 v18, -v6, v18
    v_mul_f32 v19, -v6, v19
    v_exp_f32 v16, v16
    v_exp_f32 v17, v17
    v_exp_f32 v18, v18
    v_exp_f32 v19, v19
    v_max_f32 v68, 0, v68
    v_max_f32 v69, 0, v69
    v_max_f32 v70, 0, v70
    v_max_f32 v71, 0, v71
    v_fma_f32 v68, v68, v8, v16
    v_fma_f32 v69, v69, v8, v17
    v_fma_f32 v70, v70, v8, v18
    v_fma_f32 v71, v71, v8, v19
    v_add_f32 v68, 0x358637bd, v68
    v_add_f32 v69, 0x358637bd, v69
    v_add_f32 v70, 0x358637bd, v70
    v_add_f32 v71, 0x358637bd, v71
    v_min_f32 v16, 0, v72
    v_min_f32 v17, 0, v73
    v_min_f32 v18, 0, v74
    v_min_f32 v19, 0, v75
    v_mul_f32 v16, -v6, v16
    v_mul_f32 v17, -v6, v17
    v_mul_f32 v18, -v6, v18
    v_mul_f32 v19, -v6, v19
    v_exp_f32 v16, v16
    v_exp_f32 v17, v17
    v_exp_f32 v18, v18
    v_exp_f32 v19, v19
    v_max_f32 v72, 0, v72
    v_max_f32 v73, 0, v73
    v_max_f32 v74, 0, v74
    v_max_f32 v75, 0, v75
    v_fma_f32 v72, v72, v8, v16
    v_fma_f32 v73, v73, v8, v17
    v_fma_f32 v74, v74, v8, v18
    v_fma_f32 v75, v75, v8, v19
    v_add_f32 v72, 0x358637bd, v72
    v_add_f32 v73, 0x358637bd, v73
    v_add_f32 v74, 0x358637bd, v74
    v_add_f32 v75, 0x358637bd, v75
    v_min_f32 v16, 0, v76
    v_min_f32 v17, 0, v77
    v_min_f32 v18, 0, v78
    v_min_f32 v19, 0, v79
    v_mul_f32 v16, -v6, v16
    v_mul_f32 v17, -v6, v17
    v_mul_f32 v18, -v6, v18
    v_mul_f32 v19, -v6, v19
    v_exp_f32 v16, v16
    v_exp_f32 v17, v17
    v_exp_f32 v18, v18
    v_exp_f32 v19, v19
    v_max_f32 v76, 0, v76
    v_max_f32 v77, 0, v77
    v_max_f32 v78, 0, v78
    v_max_f32 v79, 0, v79
    v_fma_f32 v76, v76, v8, v16
    v_fma_f32 v77, v77, v8, v17
    v_fma_f32 v78, v78, v8, v18
    v_fma_f32 v79, v79, v8, v19
    v_add_f32 v76, 0x358637bd, v76
    v_add_f32 v77, 0x358637bd, v77
    v_add_f32 v78, 0x358637bd, v78
    v_add_f32 v79, 0x358637bd, v79
    v_cvt_pk_bf16_f32 v64, v64, v65
    v_cvt_pk_bf16_f32 v65, v66, v67
    v_cvt_pk_bf16_f32 v66, v68, v69
    v_cvt_pk_bf16_f32 v67, v70, v71
    s_lshl_b32 s54, s45, 2
    s_lshl_b32 s55, s42, 1
    s_add_u32 s54, s54, s55
    s_add_u32 s54, s54, 112
    s_lshl_b32 s54, s54, 10
    s_add_u32 s54, s54, s50
    buffer_store_dwordx4 v[64:67], v2, s[32:35], s54 offen sc1
    v_cvt_pk_bf16_f32 v72, v72, v73
    v_cvt_pk_bf16_f32 v73, v74, v75
    v_cvt_pk_bf16_f32 v74, v76, v77
    v_cvt_pk_bf16_f32 v75, v78, v79
    s_lshl_b32 s54, s45, 2
    s_lshl_b32 s55, s42, 1
    s_add_u32 s54, s54, s55
    s_add_u32 s54, s54, 113
    s_lshl_b32 s54, s54, 10
    s_add_u32 s54, s54, s50
    buffer_store_dwordx4 v[72:75], v2, s[32:35], s54 offen sc1
    v_lshrrev_b32 v0, 2, v1
    v_and_b32 v0, 3, v0
    v_lshrrev_b32 v3, 5, v1
    v_lshlrev_b32 v3, 2, v3
    v_add_u32 v3, v3, v0
    v_lshlrev_b32 v3, 7, v3
    v_lshrrev_b32 v0, 1, v0
    v_lshlrev_b32 v0, 6, v0
    v_add_u32 v3, v3, v0
    v_lshrrev_b32 v0, 4, v1
    v_and_b32 v0, 1, v0
    v_lshlrev_b32 v0, 5, v0
    v_add_u32 v3, v3, v0
    v_and_b32 v0, 3, v1
    v_lshlrev_b32 v0, 3, v0
    v_add_u32 v3, v3, v0
    s_lshl_b32 s52, s78, 12
    v_add_u32 v24, s52, v3
    v_xor_b32 v25, 64, v24
    v_add_u32 v26, 0x10000, v24
    v_add_u32 v27, 0x10000, v25
    v_add_u32 v28, 0x20000, v24
    v_add_u32 v29, 0x20000, v25
    ds_read_b64_tr_b16 v[128:129], v28 offset:0
    ds_read_b64_tr_b16 v[130:131], v28 offset:1024
    ds_read_b64_tr_b16 v[132:133], v29 offset:0
    ds_read_b64_tr_b16 v[134:135], v29 offset:1024
    ds_read_b64_tr_b16 v[136:137], v28 offset:2048
    ds_read_b64_tr_b16 v[138:139], v28 offset:3072
    ds_read_b64_tr_b16 v[140:141], v29 offset:2048
    ds_read_b64_tr_b16 v[142:143], v29 offset:3072
    ds_read_b64_tr_b16 v[144:145], v26 offset:0
    ds_read_b64_tr_b16 v[146:147], v26 offset:1024
    ds_read_b64_tr_b16 v[148:149], v27 offset:0
    ds_read_b64_tr_b16 v[150:151], v27 offset:1024
    ds_read_b64_tr_b16 v[152:153], v26 offset:2048
    ds_read_b64_tr_b16 v[154:155], v26 offset:3072
    ds_read_b64_tr_b16 v[156:157], v27 offset:2048
    ds_read_b64_tr_b16 v[158:159], v27 offset:3072
    ds_read_b64_tr_b16 v[160:161], v26 offset:16384
    ds_read_b64_tr_b16 v[162:163], v26 offset:17408
    ds_read_b64_tr_b16 v[164:165], v27 offset:16384
    ds_read_b64_tr_b16 v[166:167], v27 offset:17408
    ds_read_b64_tr_b16 v[168:169], v26 offset:18432
    ds_read_b64_tr_b16 v[170:171], v26 offset:19456
    ds_read_b64_tr_b16 v[172:173], v27 offset:18432
    ds_read_b64_tr_b16 v[174:175], v27 offset:19456
    ds_read_b64_tr_b16 v[176:177], v26 offset:32768
    ds_read_b64_tr_b16 v[178:179], v26 offset:33792
    ds_read_b64_tr_b16 v[180:181], v27 offset:32768
    ds_read_b64_tr_b16 v[182:183], v27 offset:33792
    ds_read_b64_tr_b16 v[184:185], v26 offset:34816
    ds_read_b64_tr_b16 v[186:187], v26 offset:35840
    ds_read_b64_tr_b16 v[188:189], v27 offset:34816
    ds_read_b64_tr_b16 v[190:191], v27 offset:35840
    ds_read_b64_tr_b16 v[192:193], v26 offset:49152
    ds_read_b64_tr_b16 v[194:195], v26 offset:50176
    ds_read_b64_tr_b16 v[196:197], v27 offset:49152
    ds_read_b64_tr_b16 v[198:199], v27 offset:50176
    ds_read_b64_tr_b16 v[200:201], v26 offset:51200
    ds_read_b64_tr_b16 v[202:203], v26 offset:52224
    ds_read_b64_tr_b16 v[204:205], v27 offset:51200
    ds_read_b64_tr_b16 v[206:207], v27 offset:52224
    s_cmp_lg_u32 s40, 3
    s_cbranch_scc1 L_r3_A
    s_waitcnt vmcnt(2)
    v_add_f32 v80, v80, v84
    v_add_f32 v81, v81, v85
    v_add_f32 v82, v82, v86
    v_add_f32 v83, v83, v87
    v_add_f32_dpp v80, v80, v80 row_ror:8 row_mask:0xf bank_mask:0xf
    v_add_f32_dpp v81, v81, v81 row_ror:8 row_mask:0xf bank_mask:0xf
    v_add_f32_dpp v82, v82, v82 row_ror:8 row_mask:0xf bank_mask:0xf
    v_add_f32_dpp v83, v83, v83 row_ror:8 row_mask:0xf bank_mask:0xf
    s_waitcnt vmcnt(2)
    v_add_f32_dpp v88, v88, v88 quad_perm:[1,0,3,2] row_mask:0xf bank_mask:0xf
    v_add_f32_dpp v89, v89, v89 quad_perm:[1,0,3,2] row_mask:0xf bank_mask:0xf
    s_nop 0
    v_add_f32_dpp v88, v88, v88 quad_perm:[2,3,0,1] row_mask:0xf bank_mask:0xf
    v_add_f32_dpp v89, v89, v89 quad_perm:[2,3,0,1] row_mask:0xf bank_mask:0xf
    s_nop 0
    v_add_f32_dpp v88, v88, v88 row_half_mirror row_mask:0xf bank_mask:0xf
    v_add_f32_dpp v89, v89, v89 row_half_mirror row_mask:0xf bank_mask:0xf
    s_nop 0
    v_add_f32_dpp v88, v88, v88 row_mirror row_mask:0xf bank_mask:0xf
    v_add_f32_dpp v89, v89, v89 row_mirror row_mask:0xf bank_mask:0xf
    v_mov_b32 v90, v80
    v_mov_b32 v91, v81
    v_mov_b32 v92, v82
    v_mov_b32 v93, v83
    v_permlane16_swap_b32 v80, v90
    v_permlane16_swap_b32 v81, v91
    v_permlane16_swap_b32 v82, v92
    v_permlane16_swap_b32 v83, v93
    v_add_f32 v80, v80, v90
    v_add_f32 v81, v81, v91
    v_add_f32 v82, v82, v92
    v_add_f32 v83, v83, v93
    v_mov_b32 v90, v80
    v_mov_b32 v91, v81
    v_mov_b32 v92, v82
    v_mov_b32 v93, v83
    v_permlane32_swap_b32 v80, v90
    v_permlane32_swap_b32 v81, v91
    v_permlane32_swap_b32 v82, v92
    v_permlane32_swap_b32 v83, v93
    v_add_f32 v80, v80, v90
    v_add_f32 v81, v81, v91
    v_add_f32 v82, v82, v92
    v_add_f32 v83, v83, v93
    v_cvt_pk_bf16_f32 v80, v80, v81
    v_cvt_pk_bf16_f32 v81, v82, v83
    v_cvt_pk_bf16_f32 v88, v88, v89
    v_lshlrev_b32 v9, 3, v1
    v_mov_b32 v10, 2130706432
    v_cmp_gt_u32 vcc, 8, v1
    s_mul_i32 s54, s70, 640
    s_add_u32 s54, s54, 11534336
    v_cndmask_b32 v9, v10, v9, vcc
    s_lshl_b32 s55, s71, 6
    s_add_u32 s55, s55, s54
    buffer_store_dwordx2 v[80:81], v9, s[32:35], s55 offen sc1
    v_cmp_eq_u32 vcc, 0, v1
    v_mov_b32 v9, 0
    s_lshl_b32 s55, s71, 2
    s_add_u32 s55, s55, s54
    s_add_u32 s55, s55, 512
    v_cndmask_b32 v9, v10, v9, vcc
    buffer_store_dword v88, v9, s[32:35], s55 offen sc1
L_r3_A:
    v_and_b32 v0, 31, v1
    v_lshlrev_b32 v0, 10, v0
    v_lshrrev_b32 v3, 5, v1
    v_lshlrev_b32 v3, 3, v3
    v_add_u32 v0, v0, v3
    s_lshl_b32 s52, s64, 16
    s_lshl_b32 s53, s79, 15
    s_add_u32 s52, s52, s53
    s_lshl_b32 s53, s65, 7
    s_add_u32 s52, s52, s53
    s_lshl_b32 s53, s78, 5
    s_add_u32 s53, s52, s53
    buffer_load_dwordx2 v[6:7], v0, s[4:7], s53 offen
    buffer_load_dwordx2 v[14:15], v0, s[4:7], s53 offen offset:16
    s_mov_b32 s49, s53
    s_waitcnt vmcnt(11) lgkmcnt(15)
    v_mfma_f32_32x32x16_bf16 v[96:111], v[128:131], v[208:211], 0
    v_mfma_f32_32x32x16_bf16 v[112:127], v[132:135], v[208:211], 0
    s_waitcnt vmcnt(10)
    v_mfma_f32_32x32x16_bf16 v[96:111], v[136:139], v[212:215], v[96:111]
    v_mfma_f32_32x32x16_bf16 v[112:127], v[140:143], v[212:215], v[112:127]
    s_waitcnt vmcnt(9)
    v_mfma_f32_32x32x16_bf16 v[96:111], v[144:147], v[216:219], v[96:111]
    v_mfma_f32_32x32x16_bf16 v[112:127], v[148:151], v[216:219], v[112:127]
    s_waitcnt vmcnt(8)
    v_mfma_f32_32x32x16_bf16 v[96:111], v[152:155], v[220:223], v[96:111]
    v_mfma_f32_32x32x16_bf16 v[112:127], v[156:159], v[220:223], v[112:127]
    s_waitcnt vmcnt(7)
    v_mfma_f32_32x32x16_bf16 v[96:111], v[160:163], v[224:227], v[96:111]
    v_mfma_f32_32x32x16_bf16 v[112:127], v[164:167], v[224:227], v[112:127]
    s_waitcnt vmcnt(6)
    v_mfma_f32_32x32x16_bf16 v[96:111], v[168:171], v[228:231], v[96:111]
    v_mfma_f32_32x32x16_bf16 v[112:127], v[172:175], v[228:231], v[112:127]
    s_waitcnt vmcnt(5) lgkmcnt(14)
    v_mfma_f32_32x32x16_bf16 v[96:111], v[176:179], v[232:235], v[96:111]
    s_waitcnt lgkmcnt(12)
    v_mfma_f32_32x32x16_bf16 v[112:127], v[180:183], v[232:235], v[112:127]
    s_waitcnt vmcnt(4) lgkmcnt(10)
    v_mfma_f32_32x32x16_bf16 v[96:111], v[184:187], v[236:239], v[96:111]
    s_waitcnt lgkmcnt(8)
    v_mfma_f32_32x32x16_bf16 v[112:127], v[188:191], v[236:239], v[112:127]
    s_waitcnt vmcnt(2)
    s_waitcnt lgkmcnt(0)
    s_barrier
    s_cmp_lg_u32 s40, 3
    s_cbranch_scc1 L_r4_A
    v_mov_b32 v3, s51
    v_mov_b32 v4, 0
    s_lshl_b32 s55, s2, 2
    s_add_u32 s55, s55, 12591104
    s_mov_b64 s[68:69], exec
    s_mov_b64 exec, 1
    buffer_store_dword v3, v4, s[32:35], s55 offen sc1
    s_mov_b64 exec, s[68:69]
L_r4_A:
    s_cmp_lg_u32 s40, 0
    s_cbranch_scc1 L_fl_f1bA
    s_lshl_b32 s54, s43, 7
    s_lshl_b32 s55, s44, 2
    s_add_u32 s54, s54, s55
    s_add_u32 s54, s54, 12595200
    v_mov_b32 v9, s51
    v_mov_b32 v10, 0
    s_mov_b64 s[68:69], exec
    s_mov_b64 exec, 1
    buffer_store_dword v9, v10, s[32:35], s54 offen sc1
    s_mov_b64 exec, s[68:69]
L_fl_f1bA:
    s_add_u32 m0, s67, 0
    s_add_u32 s77, s58, 98304
    buffer_load_dwordx4 v5, s[20:23], s77 offen lds
    s_add_u32 s77, s58, 105472
    buffer_load_dwordx4 v5, s[20:23], s77 offen offset:1024 lds
    s_add_u32 m0, s67, 16384
    s_add_u32 s77, s58, 131072
    buffer_load_dwordx4 v5, s[20:23], s77 offen lds
    s_add_u32 s77, s58, 138240
    buffer_load_dwordx4 v5, s[20:23], s77 offen offset:1024 lds
    s_add_u32 m0, s67, 32768
    s_add_u32 s77, s58, 163840
    buffer_load_dwordx4 v5, s[20:23], s77 offen lds
    s_add_u32 s77, s58, 171008
    buffer_load_dwordx4 v5, s[20:23], s77 offen offset:1024 lds
    s_add_u32 m0, s67, 49152
    s_add_u32 s77, s58, 196608
    buffer_load_dwordx4 v5, s[20:23], s77 offen lds
    s_add_u32 s77, s58, 203776
    buffer_load_dwordx4 v5, s[20:23], s77 offen offset:1024 lds
    s_add_u32 m0, s67, 147456
    s_add_u32 s77, s58, 229376
    buffer_load_dwordx4 v5, s[20:23], s77 offen lds
    s_add_u32 s77, s58, 236544
    buffer_load_dwordx4 v5, s[20:23], s77 offen offset:1024 lds
    s_add_u32 m0, s67, 131072
    s_add_u32 s77, s58, 262144
    buffer_load_dwordx4 v5, s[20:23], s77 offen lds
    s_add_u32 s77, s58, 269312
    buffer_load_dwordx4 v5, s[20:23], s77 offen offset:1024 lds
    s_add_u32 m0, s67, 65536
    s_add_u32 s77, s58, 294912
    buffer_load_dwordx4 v5, s[20:23], s77 offen lds
    s_add_u32 s77, s58, 302080
    buffer_load_dwordx4 v5, s[20:23], s77 offen offset:1024 lds
    s_add_u32 m0, s67, 81920
    s_add_u32 s77, s59, 0
    buffer_load_dwordx4 v5, s[24:27], s77 offen lds
    s_add_u32 s77, s59, 7168
    buffer_load_dwordx4 v5, s[24:27], s77 offen offset:1024 lds
    s_add_u32 m0, s67, 98304
    s_add_u32 s77, s59, 32768
    buffer_load_dwordx4 v5, s[24:27], s77 offen lds
    s_add_u32 s77, s59, 39936
    buffer_load_dwordx4 v5, s[24:27], s77 offen offset:1024 lds
    s_cmp_lg_u32 s40, 4
    s_cbranch_scc1 L_tr2_A
    v_and_b32 v0, 15, v1
    v_lshlrev_b32 v0, 2, v0
    s_lshr_b32 s54, s64, 1
    s_lshl_b32 s54, s54, 7
    s_add_u32 s54, s54, 12595200
    s_mov_b32 s72, 0
L_pf1b_A:
    buffer_load_dword v3, v0, s[32:35], s54 offen sc1
    s_waitcnt vmcnt(0)
    v_cmp_eq_u32 vcc, s51, v3
    s_add_u32 s72, s72, 1
    s_cmp_gt_u32 s72, 0x80000
    s_cbranch_scc1 L_tr2_A
    s_cmp_eq_u64 vcc, exec
    s_cbranch_scc1 L_tr2_A
    s_sleep 4
    s_branch L_pf1b_A
L_tr2_A:
    s_barrier
    s_add_u32 s48, s60, 4096
    buffer_load_dwordx4 v[240:243], v2, s[32:35], s48 offen offset:0 sc1
    s_add_u32 s48, s60, 4096
    buffer_load_dwordx4 v[244:247], v2, s[32:35], s48 offen offset:1024 sc1
    s_add_u32 s48, s60, 4096
    buffer_load_dwordx4 v[248:251], v2, s[32:35], s48 offen offset:2048 sc1
    s_add_u32 s48, s60, 4096
    buffer_load_dwordx4 v[252:255], v2, s[32:35], s48 offen offset:3072 sc1
    s_add_u32 s48, s60, 8192
    buffer_load_dwordx4 v[64:67], v2, s[32:35], s48 offen offset:0 sc1
    s_add_u32 s48, s60, 8192
    buffer_load_dwordx4 v[68:71], v2, s[32:35], s48 offen offset:1024 sc1
    s_add_u32 s48, s60, 8192
    buffer_load_dwordx4 v[72:75], v2, s[32:35], s48 offen offset:2048 sc1
    s_add_u32 s48, s60, 8192
    buffer_load_dwordx4 v[76:79], v2, s[32:35], s48 offen offset:3072 sc1
    s_add_u32 s48, s60, 12288
    buffer_load_dwordx4 v[128:131], v2, s[32:35], s48 offen offset:0 sc1
    s_add_u32 s48, s60, 12288
    buffer_load_dwordx4 v[132:135], v2, s[32:35], s48 offen offset:1024 sc1
    s_add_u32 s48, s60, 12288
    buffer_load_dwordx4 v[208:211], v2, s[32:35], s48 offen offset:2048 sc1
    s_add_u32 s48, s60, 12288
    buffer_load_dwordx4 v[136:139], v2, s[32:35], s48 offen offset:3072 sc1
    s_waitcnt vmcnt(11)
    v_mfma_f32_32x32x16_bf16 v[96:111], v[192:195], v[240:243], v[96:111]
    v_mfma_f32_32x32x16_bf16 v[112:127], v[196:199], v[240:243], v[112:127]
    s_add_u32 s48, s60, 16384
    buffer_load_dwordx4 v[140:143], v2, s[32:35], s48 offen offset:0 sc1
    s_barrier
    ds_read_b64_tr_b16 v[48:49], v24 offset:0
    ds_read_b64_tr_b16 v[50:51], v24 offset:1024
    s_waitcnt vmcnt(11)
    v_mfma_f32_32x32x16_bf16 v[96:111], v[200:203], v[244:247], v[96:111]
    s_add_u32 m0, s67, 114688
    s_add_u32 s77, s59, 65536
    buffer_load_dwordx4 v5, s[24:27], s77 offen lds
    ds_read_b64_tr_b16 v[52:53], v25 offset:0
    ds_read_b64_tr_b16 v[54:55], v25 offset:1024
    v_mfma_f32_32x32x16_bf16 v[112:127], v[204:207], v[244:247], v[112:127]
    s_add_u32 s48, s60, 16384
    buffer_load_dwordx4 v[212:215], v2, s[32:35], s48 offen offset:1024 sc1
    s_add_u32 s77, s59, 72704
    buffer_load_dwordx4 v5, s[24:27], s77 offen offset:1024 lds
    ds_read_b64_tr_b16 v[56:57], v24 offset:2048
    ds_read_b64_tr_b16 v[58:59], v24 offset:3072
    s_waitcnt vmcnt(13) lgkmcnt(4)
    v_mfma_f32_32x32x16_bf16 v[96:111], v[48:51], v[248:251], v[96:111]
    ds_read_b64_tr_b16 v[60:61], v25 offset:2048
    ds_read_b64_tr_b16 v[62:63], v25 offset:3072
    s_waitcnt lgkmcnt(4)
    v_mfma_f32_32x32x16_bf16 v[112:127], v[52:55], v[248:251], v[112:127]
    s_add_u32 s48, s60, 16384
    buffer_load_dwordx4 v[144:147], v2, s[32:35], s48 offen offset:2048 sc1
    ds_read_b64_tr_b16 v[48:49], v24 offset:16384
    ds_read_b64_tr_b16 v[50:51], v24 offset:17408
    s_waitcnt vmcnt(13) lgkmcnt(4)
    v_mfma_f32_32x32x16_bf16 v[96:111], v[56:59], v[252:255], v[96:111]
    ds_read_b64_tr_b16 v[52:53], v25 offset:16384
    ds_read_b64_tr_b16 v[54:55], v25 offset:17408
    s_waitcnt lgkmcnt(4)
    v_mfma_f32_32x32x16_bf16 v[112:127], v[60:63], v[252:255], v[112:127]
    s_add_u32 s48, s60, 16384
    buffer_load_dwordx4 v[148:151], v2, s[32:35], s48 offen offset:3072 sc1
    ds_read_b64_tr_b16 v[56:57], v24 offset:18432
    ds_read_b64_tr_b16 v[58:59], v24 offset:19456
    s_waitcnt vmcnt(13) lgkmcnt(4)
    v_mfma_f32_32x32x16_bf16 v[96:111], v[48:51], v[64:67], v[96:111]
    ds_read_b64_tr_b16 v[60:61], v25 offset:18432
    ds_read_b64_tr_b16 v[62:63], v25 offset:19456
    s_waitcnt lgkmcnt(4)
    v_mfma_f32_32x32x16_bf16 v[112:127], v[52:55], v[64:67], v[112:127]
    buffer_load_dwordx4 v[216:219], v2, s[32:35], s61 offen offset:0 sc1
    ds_read_b64_tr_b16 v[48:49], v24 offset:32768
    ds_read_b64_tr_b16 v[50:51], v24 offset:33792
    s_waitcnt vmcnt(13) lgkmcnt(4)
    v_mfma_f32_32x32x16_bf16 v[96:111], v[56:59], v[68:71], v[96:111]
    ds_read_b64_tr_b16 v[52:53], v25 offset:32768
    ds_read_b64_tr_b16 v[54:55], v25 offset:33792
    s_waitcnt lgkmcnt(4)
    v_mfma_f32_32x32x16_bf16 v[112:127], v[60:63], v[68:71], v[112:127]
    buffer_load_dwordx4 v[152:155], v2, s[32:35], s61 offen offset:1024 sc1
    ds_read_b64_tr_b16 v[56:57], v24 offset:34816
    ds_read_b64_tr_b16 v[58:59], v24 offset:35840
    s_waitcnt vmcnt(13) lgkmcnt(4)
    v_mfma_f32_32x32x16_bf16 v[96:111], v[48:51], v[72:75], v[96:111]
    ds_read_b64_tr_b16 v[60:61], v25 offset:34816
    ds_read_b64_tr_b16 v[62:63], v25 offset:35840
    s_waitcnt lgkmcnt(4)
    v_mfma_f32_32x32x16_bf16 v[112:127], v[52:55], v[72:75], v[112:127]
    buffer_load_dwordx4 v[156:159], v2, s[32:35], s61 offen offset:2048 sc1
    ds_read_b64_tr_b16 v[48:49], v24 offset:49152
    ds_read_b64_tr_b16 v[50:51], v24 offset:50176
    s_waitcnt vmcnt(13) lgkmcnt(4)
    v_mfma_f32_32x32x16_bf16 v[96:111], v[56:59], v[76:79], v[96:111]
    ds_read_b64_tr_b16 v[52:53], v25 offset:49152
    ds_read_b64_tr_b16 v[54:55], v25 offset:50176
    s_waitcnt lgkmcnt(4)
    v_mfma_f32_32x32x16_bf16 v[112:127], v[60:63], v[76:79], v[112:127]
    buffer_load_dwordx4 v[220:223], v2, s[32:35], s61 offen offset:3072 sc1
    ds_read_b64_tr_b16 v[56:57], v24 offset:51200
    ds_read_b64_tr_b16 v[58:59], v24 offset:52224
    s_cmp_lg_u32 s40, 6
    s_cbranch_scc1 L_f3i_A
    v_lshlrev_b32 v0, 4, v1
    v_add_u32 v0, 12591104, v0
    buffer_load_dwordx4 v[16:19], v0, s[32:35], 0 offen sc1
L_f3i_A:
    s_waitcnt vmcnt(13) lgkmcnt(4)
    v_mfma_f32_32x32x16_bf16 v[96:111], v[48:51], v[128:131], v[96:111]
    ds_read_b64_tr_b16 v[60:61], v25 offset:51200
    ds_read_b64_tr_b16 v[62:63], v25 offset:52224
    s_waitcnt lgkmcnt(4)
    v_mfma_f32_32x32x16_bf16 v[112:127], v[52:55], v[128:131], v[112:127]
    s_add_u32 s48, s61, 4096
    buffer_load_dwordx4 v[160:163], v2, s[32:35], s48 offen offset:0 sc1
    s_cmp_lg_u32 s40, 6
    s_cbranch_scc1 L_f3ok_A
    s_waitcnt vmcnt(1)
    v_cmp_eq_u32 vcc, s51, v16
    v_cmp_eq_u32 s[68:69], s51, v17
    s_nop 1
    s_and_b64 vcc, vcc, s[68:69]
    v_cmp_eq_u32 s[68:69], s51, v18
    s_nop 1
    s_and_b64 vcc, vcc, s[68:69]
    v_cmp_eq_u32 s[68:69], s51, v19
    s_nop 1
    s_and_b64 vcc, vcc, s[68:69]
    s_mov_b32 s72, 0
    s_cmp_eq_u64 vcc, exec
    s_cbranch_scc1 L_f3ok_A
    v_lshlrev_b32 v0, 4, v1
    v_add_u32 v0, 12591104, v0
L_f3l_A:
    buffer_load_dwordx4 v[16:19], v0, s[32:35], 0 offen sc1
    s_waitcnt vmcnt(0)
    v_cmp_eq_u32 vcc, s51, v16
    v_cmp_eq_u32 s[68:69], s51, v17
    s_nop 1
    s_and_b64 vcc, vcc, s[68:69]
    v_cmp_eq_u32 s[68:69], s51, v18
    s_nop 1
    s_and_b64 vcc, vcc, s[68:69]
    v_cmp_eq_u32 s[68:69], s51, v19
    s_nop 1
    s_and_b64 vcc, vcc, s[68:69]
    s_add_u32 s72, s72, 1
    s_cmp_gt_u32 s72, 0x80000
    s_cbranch_scc1 L_f3ok_A
    s_cmp_eq_u64 vcc, exec
    s_cbranch_scc1 L_f3ok_A
    s_sleep 4
    s_branch L_f3l_A
L_f3ok_A:
    s_barrier
    v_and_b32 v0, 31, v1
    v_lshlrev_b32 v3, 5, v0
    v_mov_b32 v4, 2130706432
    v_cmp_gt_u32 vcc, 16, v0
    v_and_b32 v80, 27, v0
    s_nop 0
    v_cndmask_b32 v3, v4, v3, vcc
    v_cmp_eq_u32 vcc, 16, v80
    v_mov_b32 v4, 512
    v_lshrrev_b32 v0, 5, v1
    v_cndmask_b32 v3, v3, v4, vcc
    v_lshlrev_b32 v0, 4, v0
    v_add_u32 v3, v3, v0
    s_mul_i32 s53, s78, 5120
    s_add_u32 s53, s53, 11534336
    buffer_load_dwordx4 v[164:167], v3, s[32:35], s53 offen offset:0 sc1
    buffer_load_dwordx4 v[224:227], v3, s[32:35], s53 offen offset:640 sc1
    buffer_load_dwordx4 v[168:171], v3, s[32:35], s53 offen offset:1280 sc1
    buffer_load_dwordx4 v[172:175], v3, s[32:35], s53 offen offset:1920 sc1
    buffer_load_dwordx4 v[228:231], v3, s[32:35], s53 offen offset:2560 sc1
    buffer_load_dwordx4 v[176:179], v3, s[32:35], s53 offen offset:3200 sc1
    buffer_load_dwordx4 v[180:183], v3, s[32:35], s53 offen offset:3840 sc1
    s_add_u32 s53, s53, 4480
    buffer_load_dwordx4 v[232:235], v3, s[32:35], s53 offen sc1
    ds_read_b64_tr_b16 v[48:49], v28 offset:16384
    ds_read_b64_tr_b16 v[50:51], v28 offset:17408
    s_waitcnt vmcnt(21) lgkmcnt(4)
    v_mfma_f32_32x32x16_bf16 v[96:111], v[56:59], v[132:135], v[96:111]
    s_add_u32 m0, s67, 0
    s_add_u32 s77, s59, 98304
    buffer_load_dwordx4 v5, s[24:27], s77 offen lds
    ds_read_b64_tr_b16 v[52:53], v29 offset:16384
    ds_read_b64_tr_b16 v[54:55], v29 offset:17408
    s_waitcnt lgkmcnt(4)
    v_mfma_f32_32x32x16_bf16 v[112:127], v[60:63], v[132:135], v[112:127]
    s_add_u32 s48, s61, 4096
    buffer_load_dwordx4 v[184:187], v2, s[32:35], s48 offen offset:1024 sc1
    s_add_u32 s77, s59, 105472
    buffer_load_dwordx4 v5, s[24:27], s77 offen offset:1024 lds
    s_add_u32 m0, s67, 16384
    ds_read_b64_tr_b16 v[56:57], v28 offset:18432
    ds_read_b64_tr_b16 v[58:59], v28 offset:19456
    s_waitcnt vmcnt(23) lgkmcnt(4)
    v_mfma_f32_32x32x16_bf16 v[96:111], v[48:51], v[208:211], v[96:111]
    s_add_u32 s77, s58, 393216
    buffer_load_dwordx4 v5, s[20:23], s77 offen lds
    s_add_u32 s77, s58, 400384
    ds_read_b64_tr_b16 v[60:61], v29 offset:18432
    ds_read_b64_tr_b16 v[62:63], v29 offset:19456
    s_waitcnt lgkmcnt(4)
    v_mfma_f32_32x32x16_bf16 v[112:127], v[52:55], v[208:211], v[112:127]
    s_add_u32 s48, s61, 4096
    buffer_load_dwordx4 v[188:191], v2, s[32:35], s48 offen offset:2048 sc1
    buffer_load_dwordx4 v5, s[20:23], s77 offen offset:1024 lds
    s_add_u32 m0, s67, 32768
    s_add_u32 s77, s58, 425984
    buffer_load_dwordx4 v5, s[20:23], s77 offen lds
    s_add_u32 s77, s58, 433152
    buffer_load_dwordx4 v5, s[20:23], s77 offen offset:1024 lds
    s_waitcnt vmcnt(23)
    s_barrier
    ds_read_b64_tr_b16 v[48:49], v28 offset:0
    ds_read_b64_tr_b16 v[50:51], v28 offset:1024
    s_waitcnt lgkmcnt(4)
    v_mfma_f32_32x32x16_bf16 v[96:111], v[56:59], v[136:139], v[96:111]
    ds_read_b64_tr_b16 v[52:53], v29 offset:0
    ds_read_b64_tr_b16 v[54:55], v29 offset:1024
    s_waitcnt lgkmcnt(4)
    v_mfma_f32_32x32x16_bf16 v[112:127], v[60:63], v[136:139], v[112:127]
    s_add_u32 s48, s61, 4096
    buffer_load_dwordx4 v[236:239], v2, s[32:35], s48 offen offset:3072 sc1
    ds_read_b64_tr_b16 v[56:57], v28 offset:2048
    ds_read_b64_tr_b16 v[58:59], v28 offset:3072
    s_waitcnt lgkmcnt(4)
    v_mfma_f32_32x32x16_bf16 v[96:111], v[48:51], v[140:143], v[96:111]
    ds_read_b64_tr_b16 v[60:61], v29 offset:2048
    ds_read_b64_tr_b16 v[62:63], v29 offset:3072
    s_waitcnt lgkmcnt(4)
    v_mfma_f32_32x32x16_bf16 v[112:127], v[52:55], v[140:143], v[112:127]
    s_add_u32 s48, s60, 24576
    buffer_load_dwordx4 v[192:195], v2, s[32:35], s48 offen offset:0 sc1
    ds_read_b64_tr_b16 v[48:49], v26 offset:0
    ds_read_b64_tr_b16 v[50:51], v26 offset:1024
    s_waitcnt lgkmcnt(4)
    v_mfma_f32_32x32x16_bf16 v[96:111], v[56:59], v[212:215], v[96:111]
    ds_read_b64_tr_b16 v[52:53], v27 offset:0
    ds_read_b64_tr_b16 v[54:55], v27 offset:1024
    s_waitcnt lgkmcnt(4)
    v_mfma_f32_32x32x16_bf16 v[112:127], v[60:63], v[212:215], v[112:127]
    s_add_u32 s48, s60, 24576
    buffer_load_dwordx4 v[196:199], v2, s[32:35], s48 offen offset:1024 sc1
    ds_read_b64_tr_b16 v[56:57], v26 offset:2048
    ds_read_b64_tr_b16 v[58:59], v26 offset:3072
    s_waitcnt vmcnt(25) lgkmcnt(4)
    v_mfma_f32_32x32x16_bf16 v[96:111], v[48:51], v[144:147], v[96:111]
    ds_read_b64_tr_b16 v[60:61], v27 offset:2048
    ds_read_b64_tr_b16 v[62:63], v27 offset:3072
    s_waitcnt lgkmcnt(4)
    v_mfma_f32_32x32x16_bf16 v[112:127], v[52:55], v[144:147], v[112:127]
    s_add_u32 s48, s60, 24576
    buffer_load_dwordx4 v[240:243], v2, s[32:35], s48 offen offset:2048 sc1
    ds_read_b64_tr_b16 v[48:49], v26 offset:16384
    ds_read_b64_tr_b16 v[50:51], v26 offset:17408
    s_waitcnt vmcnt(19)
    v_mfma_f32_32x32x16_bf16 v[80:95], v[164:167], v[216:219], 0
    s_waitcnt lgkmcnt(4)
    v_mfma_f32_32x32x16_bf16 v[96:111], v[56:59], v[148:151], v[96:111]
    ds_read_b64_tr_b16 v[52:53], v27 offset:16384
    ds_read_b64_tr_b16 v[54:55], v27 offset:17408
    s_waitcnt lgkmcnt(4)
    v_mfma_f32_32x32x16_bf16 v[112:127], v[60:63], v[148:151], v[112:127]
    s_add_u32 s48, s60, 24576
    buffer_load_dwordx4 v[200:203], v2, s[32:35], s48 offen offset:3072 sc1
    ds_read_b64_tr_b16 v[56:57], v26 offset:18432
    ds_read_b64_tr_b16 v[58:59], v26 offset:19456
    s_nop 1
    v_add_f32 v88, 0x358637bd, v88
    v_rcp_f32 v88, v88
    s_nop 0
    v_mul_f32 v80, v80, v88
    v_mul_f32 v81, v81, v88
    v_mul_f32 v82, v82, v88
    v_mul_f32 v83, v83, v88
    v_mul_f32 v84, v84, v88
    v_mul_f32 v85, v85, v88
    v_mul_f32 v86, v86, v88
    v_mul_f32 v87, v87, v88
    v_cvt_pk_bf16_f32 v216, v80, v81
    v_cvt_pk_bf16_f32 v217, v82, v83
    v_cvt_pk_bf16_f32 v218, v84, v85
    v_cvt_pk_bf16_f32 v219, v86, v87
    s_waitcnt vmcnt(19)
    v_mfma_f32_32x32x16_bf16 v[80:95], v[224:227], v[152:155], 0
    s_waitcnt lgkmcnt(4)
    v_mfma_f32_32x32x16_bf16 v[96:111], v[48:51], v[216:219], v[96:111]
    ds_read_b64_tr_b16 v[60:61], v27 offset:18432
    ds_read_b64_tr_b16 v[62:63], v27 offset:19456
    s_waitcnt lgkmcnt(4)
    v_mfma_f32_32x32x16_bf16 v[112:127], v[52:55], v[216:219], v[112:127]
    ds_read_b64_tr_b16 v[48:49], v26 offset:32768
    ds_read_b64_tr_b16 v[50:51], v26 offset:33792
    s_nop 3
    v_add_f32 v88, 0x358637bd, v88
    v_rcp_f32 v88, v88
    s_nop 0
    v_mul_f32 v80, v80, v88
    v_mul_f32 v81, v81, v88
    v_mul_f32 v82, v82, v88
    v_mul_f32 v83, v83, v88
    v_mul_f32 v84, v84, v88
    v_mul_f32 v85, v85, v88
    v_mul_f32 v86, v86, v88
    v_mul_f32 v87, v87, v88
    v_cvt_pk_bf16_f32 v152, v80, v81
    v_cvt_pk_bf16_f32 v153, v82, v83
    v_cvt_pk_bf16_f32 v154, v84, v85
    v_cvt_pk_bf16_f32 v155, v86, v87
    s_waitcnt vmcnt(18)
    v_mfma_f32_32x32x16_bf16 v[80:95], v[168:171], v[156:159], 0
    s_waitcnt lgkmcnt(4)
    v_mfma_f32_32x32x16_bf16 v[96:111], v[56:59], v[152:155], v[96:111]
    ds_read_b64_tr_b16 v[52:53], v27 offset:32768
    ds_read_b64_tr_b16 v[54:55], v27 offset:33792
    s_waitcnt lgkmcnt(4)
    v_mfma_f32_32x32x16_bf16 v[112:127], v[60:63], v[152:155], v[112:127]
    ds_read_b64_tr_b16 v[56:57], v26 offset:34816
    ds_read_b64_tr_b16 v[58:59], v26 offset:35840
    s_nop 3
    v_add_f32 v88, 0x358637bd, v88
    v_rcp_f32 v88, v88
    s_nop 0
    v_mul_f32 v80, v80, v88
    v_mul_f32 v81, v81, v88
    v_mul_f32 v82, v82, v88
    v_mul_f32 v83, v83, v88
    v_mul_f32 v84, v84, v88
    v_mul_f32 v85, v85, v88
    v_mul_f32 v86, v86, v88
    v_mul_f32 v87, v87, v88
    v_cvt_pk_bf16_f32 v156, v80, v81
    v_cvt_pk_bf16_f32 v157, v82, v83
    v_cvt_pk_bf16_f32 v158, v84, v85
    v_cvt_pk_bf16_f32 v159, v86, v87
    s_waitcnt vmcnt(17)
    v_mfma_f32_32x32x16_bf16 v[80:95], v[172:175], v[220:223], 0
    s_waitcnt lgkmcnt(4)
    v_mfma_f32_32x32x16_bf16 v[96:111], v[48:51], v[156:159], v[96:111]
    ds_read_b64_tr_b16 v[60:61], v27 offset:34816
    ds_read_b64_tr_b16 v[62:63], v27 offset:35840
    s_waitcnt lgkmcnt(4)
    v_mfma_f32_32x32x16_bf16 v[112:127], v[52:55], v[156:159], v[112:127]
    ds_read_b64_tr_b16 v[48:49], v26 offset:49152
    ds_read_b64_tr_b16 v[50:51], v26 offset:50176
    s_nop 3
    v_add_f32 v88, 0x358637bd, v88
    v_rcp_f32 v88, v88
    s_nop 0
    v_mul_f32 v80, v80, v88
    v_mul_f32 v81, v81, v88
    v_mul_f32 v82, v82, v88
    v_mul_f32 v83, v83, v88
    v_mul_f32 v84, v84, v88
    v_mul_f32 v85, v85, v88
    v_mul_f32 v86, v86, v88
    v_mul_f32 v87, v87, v88
    v_cvt_pk_bf16_f32 v220, v80, v81
    v_cvt_pk_bf16_f32 v221, v82, v83
    v_cvt_pk_bf16_f32 v222, v84, v85
    v_cvt_pk_bf16_f32 v223, v86, v87
    s_waitcnt vmcnt(16)
    v_mfma_f32_32x32x16_bf16 v[80:95], v[228:231], v[160:163], 0
    s_waitcnt lgkmcnt(4)
    v_mfma_f32_32x32x16_bf16 v[96:111], v[56:59], v[220:223], v[96:111]
    ds_read_b64_tr_b16 v[52:53], v27 offset:49152
    ds_read_b64_tr_b16 v[54:55], v27 offset:50176
    s_waitcnt lgkmcnt(4)
    v_mfma_f32_32x32x16_bf16 v[112:127], v[60:63], v[220:223], v[112:127]
    ds_read_b64_tr_b16 v[56:57], v26 offset:51200
    ds_read_b64_tr_b16 v[58:59], v26 offset:52224
    s_nop 3
    v_add_f32 v88, 0x358637bd, v88
    v_rcp_f32 v88, v88
    s_nop 0
    v_mul_f32 v80, v80, v88
    v_mul_f32 v81, v81, v88
    v_mul_f32 v82, v82, v88
    v_mul_f32 v83, v83, v88
    v_mul_f32 v84, v84, v88
    v_mul_f32 v85, v85, v88
    v_mul_f32 v86, v86, v88
    v_mul_f32 v87, v87, v88
    v_cvt_pk_bf16_f32 v160, v80, v81
    v_cvt_pk_bf16_f32 v161, v82, v83
    v_cvt_pk_bf16_f32 v162, v84, v85
    v_cvt_pk_bf16_f32 v163, v86, v87
    s_waitcnt vmcnt(11)
    v_mfma_f32_32x32x16_bf16 v[80:95], v[176:179], v[184:187], 0
    s_waitcnt lgkmcnt(4)
    v_mfma_f32_32x32x16_bf16 v[96:111], v[48:51], v[160:163], v[96:111]
    ds_read_b64_tr_b16 v[60:61], v27 offset:51200
    ds_read_b64_tr_b16 v[62:63], v27 offset:52224
    s_waitcnt lgkmcnt(4)
    v_mfma_f32_32x32x16_bf16 v[112:127], v[52:55], v[160:163], v[112:127]
    s_waitcnt vmcnt(5)
    s_barrier
    ds_read_b64_tr_b16 v[48:49], v24 offset:0
    ds_read_b64_tr_b16 v[50:51], v24 offset:1024
    s_nop 1
    v_add_f32 v88, 0x358637bd, v88
    v_rcp_f32 v88, v88
    s_nop 0
    v_mul_f32 v80, v80, v88
    v_mul_f32 v81, v81, v88
    v_mul_f32 v82, v82, v88
    v_mul_f32 v83, v83, v88
    v_mul_f32 v84, v84, v88
    v_mul_f32 v85, v85, v88
    v_mul_f32 v86, v86, v88
    v_mul_f32 v87, v87, v88
    v_cvt_pk_bf16_f32 v184, v80, v81
    v_cvt_pk_bf16_f32 v185, v82, v83
    v_cvt_pk_bf16_f32 v186, v84, v85
    v_cvt_pk_bf16_f32 v187, v86, v87
    v_mfma_f32_32x32x16_bf16 v[80:95], v[180:183], v[188:191], 0
    s_waitcnt lgkmcnt(4)
    v_mfma_f32_32x32x16_bf16 v[96:111], v[56:59], v[184:187], v[96:111]
    ds_read_b64_tr_b16 v[52:53], v25 offset:0
    ds_read_b64_tr_b16 v[54:55], v25 offset:1024
    s_waitcnt lgkmcnt(4)
    v_mfma_f32_32x32x16_bf16 v[112:127], v[60:63], v[184:187], v[112:127]
    ds_read_b64_tr_b16 v[56:57], v24 offset:2048
    ds_read_b64_tr_b16 v[58:59], v24 offset:3072
    s_nop 3
    v_add_f32 v88, 0x358637bd, v88
    v_rcp_f32 v88, v88
    s_nop 0
    v_mul_f32 v80, v80, v88
    v_mul_f32 v81, v81, v88
    v_mul_f32 v82, v82, v88
    v_mul_f32 v83, v83, v88
    v_mul_f32 v84, v84, v88
    v_mul_f32 v85, v85, v88
    v_mul_f32 v86, v86, v88
    v_mul_f32 v87, v87, v88
    v_cvt_pk_bf16_f32 v188, v80, v81
    v_cvt_pk_bf16_f32 v189, v82, v83
    v_cvt_pk_bf16_f32 v190, v84, v85
    v_cvt_pk_bf16_f32 v191, v86, v87
    s_waitcnt vmcnt(4)
    v_mfma_f32_32x32x16_bf16 v[80:95], v[232:235], v[236:239], 0
    s_waitcnt lgkmcnt(4)
    v_mfma_f32_32x32x16_bf16 v[96:111], v[48:51], v[188:191], v[96:111]
    ds_read_b64_tr_b16 v[60:61], v25 offset:2048
    ds_read_b64_tr_b16 v[62:63], v25 offset:3072
    s_waitcnt lgkmcnt(4)
    v_mfma_f32_32x32x16_bf16 v[112:127], v[52:55], v[188:191], v[112:127]
    ds_read_b64_tr_b16 v[48:49], v24 offset:16384
    ds_read_b64_tr_b16 v[50:51], v24 offset:17408
    s_nop 3
    v_add_f32 v88, 0x358637bd, v88
    v_rcp_f32 v88, v88
    s_nop 0
    v_mul_f32 v80, v80, v88
    v_mul_f32 v81, v81, v88
    v_mul_f32 v82, v82, v88
    v_mul_f32 v83, v83, v88
    v_mul_f32 v84, v84, v88
    v_mul_f32 v85, v85, v88
    v_mul_f32 v86, v86, v88
    v_mul_f32 v87, v87, v88
    v_cvt_pk_bf16_f32 v236, v80, v81
    v_cvt_pk_bf16_f32 v237, v82, v83
    v_cvt_pk_bf16_f32 v238, v84, v85
    v_cvt_pk_bf16_f32 v239, v86, v87
    s_waitcnt lgkmcnt(4)
    s_nop 0
    v_mfma_f32_32x32x16_bf16 v[96:111], v[56:59], v[236:239], v[96:111]
    ds_read_b64_tr_b16 v[52:53], v25 offset:16384
    ds_read_b64_tr_b16 v[54:55], v25 offset:17408
    s_waitcnt lgkmcnt(4)
    v_mfma_f32_32x32x16_bf16 v[112:127], v[60:63], v[236:239], v[112:127]
    ds_read_b64_tr_b16 v[56:57], v24 offset:18432
    ds_read_b64_tr_b16 v[58:59], v24 offset:19456
    s_waitcnt vmcnt(3) lgkmcnt(4)
    v_mfma_f32_32x32x16_bf16 v[96:111], v[48:51], v[192:195], v[96:111]
    ds_read_b64_tr_b16 v[60:61], v25 offset:18432
    ds_read_b64_tr_b16 v[62:63], v25 offset:19456
    s_waitcnt lgkmcnt(4)
    v_mfma_f32_32x32x16_bf16 v[112:127], v[52:55], v[192:195], v[112:127]
    ds_read_b64_tr_b16 v[48:49], v24 offset:32768
    ds_read_b64_tr_b16 v[50:51], v24 offset:33792
    s_waitcnt vmcnt(2) lgkmcnt(4)
    v_mfma_f32_32x32x16_bf16 v[96:111], v[56:59], v[196:199], v[96:111]
    ds_read_b64_tr_b16 v[52:53], v25 offset:32768
    ds_read_b64_tr_b16 v[54:55], v25 offset:33792
    s_waitcnt lgkmcnt(4)
    v_mfma_f32_32x32x16_bf16 v[112:127], v[60:63], v[196:199], v[112:127]
    ds_read_b64_tr_b16 v[56:57], v24 offset:34816
    ds_read_b64_tr_b16 v[58:59], v24 offset:35840
    s_waitcnt vmcnt(1) lgkmcnt(4)
    v_mfma_f32_32x32x16_bf16 v[96:111], v[48:51], v[240:243], v[96:111]
    ds_read_b64_tr_b16 v[60:61], v25 offset:34816
    ds_read_b64_tr_b16 v[62:63], v25 offset:35840
    s_waitcnt lgkmcnt(4)
    v_mfma_f32_32x32x16_bf16 v[112:127], v[52:55], v[240:243], v[112:127]
    s_waitcnt vmcnt(0) lgkmcnt(2)
    v_mfma_f32_32x32x16_bf16 v[96:111], v[56:59], v[200:203], v[96:111]
    s_waitcnt lgkmcnt(0)
    v_mfma_f32_32x32x16_bf16 v[112:127], v[60:63], v[200:203], v[112:127]
    s_waitcnt lgkmcnt(0)
    s_barrier
    s_lshl_b32 s52, s79, 15
    s_lshl_b32 s53, s78, 11
    s_add_u32 s52, s52, s53
    v_add_u32 v0, s52, v2
    s_cmp_lg_u32 s78, 0
    s_cbranch_scc1 L_rw0_A
    s_nop 1
    ds_write_b128 v0, v[104:107] offset:8192
    ds_write_b128 v0, v[108:111] offset:9216
    ds_write_b128 v0, v[112:115] offset:16384
    ds_write_b128 v0, v[116:119] offset:17408
    ds_write_b128 v0, v[120:123] offset:24576
    ds_write_b128 v0, v[124:127] offset:25600
    v_mov_b32 v128, v96
    v_mov_b32 v129, v97
    v_mov_b32 v130, v98
    v_mov_b32 v131, v99
    v_mov_b32 v132, v100
    v_mov_b32 v133, v101
    v_mov_b32 v134, v102
    v_mov_b32 v135, v103
L_rw0_A:
    s_cmp_lg_u32 s78, 1
    s_cbranch_scc1 L_rw1_A
    ds_write_b128 v0, v[96:99] offset:0
    ds_write_b128 v0, v[100:103] offset:1024
    ds_write_b128 v0, v[112:115] offset:16384
    ds_write_b128 v0, v[116:119] offset:17408
    ds_write_b128 v0, v[120:123] offset:24576
    ds_write_b128 v0, v[124:127] offset:25600
    v_mov_b32 v128, v104
    v_mov_b32 v129, v105
    v_mov_b32 v130, v106
    v_mov_b32 v131, v107
    v_mov_b32 v132, v108
    v_mov_b32 v133, v109
    v_mov_b32 v134, v110
    v_mov_b32 v135, v111
L_rw1_A:
    s_cmp_lg_u32 s78, 2
    s_cbranch_scc1 L_rw2_A
    ds_write_b128 v0, v[96:99] offset:0
    ds_write_b128 v0, v[100:103] offset:1024
    ds_write_b128 v0, v[104:107] offset:8192
    ds_write_b128 v0, v[108:111] offset:9216
    ds_write_b128 v0, v[120:123] offset:24576
    ds_write_b128 v0, v[124:127] offset:25600
    v_mov_b32 v128, v112
    v_mov_b32 v129, v113
    v_mov_b32 v130, v114
    v_mov_b32 v131, v115
    v_mov_b32 v132, v116
    v_mov_b32 v133, v117
    v_mov_b32 v134, v118
    v_mov_b32 v135, v119
L_rw2_A:
    s_cmp_lg_u32 s78, 3
    s_cbranch_scc1 L_rw3_A
    ds_write_b128 v0, v[96:99] offset:0
    ds_write_b128 v0, v[100:103] offset:1024
    ds_write_b128 v0, v[104:107] offset:8192
    ds_write_b128 v0, v[108:111] offset:9216
    ds_write_b128 v0, v[112:115] offset:16384
    ds_write_b128 v0, v[116:119] offset:17408
    v_mov_b32 v128, v120
    v_mov_b32 v129, v121
    v_mov_b32 v130, v122
    v_mov_b32 v131, v123
    v_mov_b32 v132, v124
    v_mov_b32 v133, v125
    v_mov_b32 v134, v126
    v_mov_b32 v135, v127
L_rw3_A:
    s_waitcnt lgkmcnt(0)
    s_barrier
    s_xor_b32 s53, s78, 1
    s_lshl_b32 s53, s53, 11
    s_lshl_b32 s52, s79, 15
    s_add_u32 s53, s53, s52
    s_lshl_b32 s52, s78, 13
    s_add_u32 s53, s53, s52
    v_add_u32 v81, s53, v2
    ds_read_b128 v[136:139], v81
    ds_read_b128 v[140:143], v81 offset:1024
    s_xor_b32 s53, s78, 2
    s_lshl_b32 s53, s53, 11
    s_lshl_b32 s52, s79, 15
    s_add_u32 s53, s53, s52
    s_lshl_b32 s52, s78, 13
    s_add_u32 s53, s53, s52
    v_add_u32 v82, s53, v2
    ds_read_b128 v[144:147], v82
    ds_read_b128 v[148:151], v82 offset:1024
    s_xor_b32 s53, s78, 3
    s_lshl_b32 s53, s53, 11
    s_lshl_b32 s52, s79, 15
    s_add_u32 s53, s53, s52
    s_lshl_b32 s52, s78, 13
    s_add_u32 s53, s53, s52
    v_add_u32 v83, s53, v2
    ds_read_b128 v[152:155], v83
    ds_read_b128 v[156:159], v83 offset:1024
    s_waitcnt lgkmcnt(5)
    v_add_f32 v128, v128, v136
    s_waitcnt lgkmcnt(1)
    v_add_f32 v144, v144, v152
    v_add_f32 v129, v129, v137
    v_add_f32 v145, v145, v153
    v_add_f32 v130, v130, v138
    v_add_f32 v146, v146, v154
    v_add_f32 v131, v131, v139
    v_add_f32 v147, v147, v155
    v_add_f32 v132, v132, v140
    s_waitcnt lgkmcnt(0)
    v_add_f32 v148, v148, v156
    v_add_f32 v133, v133, v141
    v_add_f32 v149, v149, v157
    v_add_f32 v134, v134, v142
    v_add_f32 v150, v150, v158
    v_add_f32 v135, v135, v143
    v_add_f32 v151, v151, v159
    v_add_f32 v128, v128, v144
    v_add_f32 v129, v129, v145
    v_add_f32 v130, v130, v146
    v_add_f32 v131, v131, v147
    v_add_f32 v132, v132, v148
    v_add_f32 v133, v133, v149
    v_add_f32 v134, v134, v150
    v_add_f32 v135, v135, v151
    v_lshlrev_b32 v136, 16, v6
    v_and_b32 v137, 0xffff0000, v6
    v_lshlrev_b32 v138, 16, v7
    v_and_b32 v139, 0xffff0000, v7
    v_add_f32 v128, v128, v136
    v_add_f32 v129, v129, v137
    v_add_f32 v130, v130, v138
    v_add_f32 v131, v131, v139
    v_lshlrev_b32 v136, 16, v14
    v_and_b32 v137, 0xffff0000, v14
    v_lshlrev_b32 v138, 16, v15
    v_and_b32 v139, 0xffff0000, v15
    v_add_f32 v132, v132, v136
    v_add_f32 v133, v133, v137
    v_add_f32 v134, v134, v138
    v_add_f32 v135, v135, v139
    v_cvt_pk_bf16_f32 v144, v128, v129
    v_cvt_pk_bf16_f32 v145, v130, v131
    v_cvt_pk_bf16_f32 v146, v132, v133
    v_cvt_pk_bf16_f32 v147, v134, v135
    v_and_b32 v0, 31, v1
    v_lshlrev_b32 v0, 10, v0
    v_lshrrev_b32 v3, 5, v1
    v_lshlrev_b32 v3, 4, v3
    v_add_u32 v0, v0, v3
    v_permlane32_swap_b32 v144, v146
    v_permlane32_swap_b32 v145, v147
    buffer_store_dwordx4 v[144:147], v0, s[28:31], s49 offen
    s_waitcnt vmcnt(0) lgkmcnt(0)
    s_endpgm
L_typeB:
    v_lshrrev_b32 v3, 3, v1
    v_and_b32 v4, 7, v1
    v_and_b32 v12, 2, v3
    v_lshlrev_b32 v12, 1, v12
    v_xor_b32 v4, v4, v12
    v_lshlrev_b32 v4, 4, v4
    v_mul_u32_u24 v3, 3072, v3
    v_add_u32 v3, v3, v4
    s_mul_i32 s48, s40, 24576
    s_lshl_b32 s77, s45, 7
    s_add_u32 s48, s48, s77
    s_add_u32 s48, s48, 1024
    s_add_u32 m0, s63, 65536
    s_add_u32 s77, s47, 0
    buffer_load_dwordx4 v96, s[4:7], s77 offen lds
    s_add_u32 s77, s47, 7168
    buffer_load_dwordx4 v97, s[4:7], s77 offen offset:1024 lds
    s_add_u32 m0, s63, 0
    s_add_u32 s77, s48, 0
    buffer_load_dwordx4 v3, s[8:11], s77 offen lds
    buffer_load_dwordx4 v3, s[8:11], s77 offen offset:1024 lds
    s_add_u32 m0, s63, 81920
    s_add_u32 s77, s47, 128
    buffer_load_dwordx4 v96, s[4:7], s77 offen lds
    s_add_u32 s77, s47, 7296
    buffer_load_dwordx4 v97, s[4:7], s77 offen offset:1024 lds
    s_add_u32 m0, s63, 16384
    s_add_u32 s77, s48, 196608
    buffer_load_dwordx4 v3, s[8:11], s77 offen lds
    buffer_load_dwordx4 v3, s[8:11], s77 offen offset:1024 lds
    s_or_b32 s52, s2, s40
    s_cmp_lg_u32 s52, 0
    s_cbranch_scc1 L_nononce_B
    s_memrealtime s[74:75]
    s_waitcnt lgkmcnt(0)
    s_or_b32 s52, s74, 1
    v_mov_b32 v9, s52
    v_mov_b32 v10, 0
    buffer_store_dword v9, v10, s[36:39], 0 offen sc1
L_nononce_B:
    s_lshl_b32 s52, s43, 7
    s_lshl_b32 s53, s44, 3
    s_add_u32 s52, s52, s53
    s_add_u32 s52, s52, s40
    s_lshl_b32 s52, s52, 10
    buffer_load_dwordx4 v[104:107], v2, s[4:7], s52 offen
    s_lshl_b32 s52, s43, 2
    s_add_u32 s52, s52, s41
    s_mul_i32 s50, s52, 147456
    s_add_u32 s50, s50, 0
    s_mov_b32 s56, 0xffff0000
    s_mov_b32 s57, 0xffff0000
    s_mul_i32 s66, s43, 36864
    s_lshl_b32 s52, s45, 2
    s_lshl_b32 s53, s42, 1
    s_add_u32 s52, s52, s53
    s_mul_i32 s52, s52, 1152
    s_add_u32 s66, s66, s52
    s_add_u32 s66, s66, 10485760
    s_and_b32 s78, s40, 3
    s_lshr_b32 s79, s40, 2
    s_lshl_b32 s67, s78, 12
    s_lshl_b32 s52, s79, 11
    s_add_u32 s67, s67, s52
    s_lshl_b32 s53, s79, 14
    s_lshl_b32 s54, s65, 7
    s_add_u32 s53, s53, s54
    s_mul_i32 s58, s78, 458752
    s_add_u32 s58, s58, s53
    s_lshl_b32 s59, s78, 17
    s_add_u32 s59, s59, s53
    v_lshrrev_b32 v9, 3, v1
    v_and_b32 v10, 7, v1
    v_and_b32 v11, 2, v9
    v_lshlrev_b32 v11, 1, v11
    v_xor_b32 v10, v10, v11
    v_lshlrev_b32 v10, 4, v10
    v_lshlrev_b32 v9, 10, v9
    v_add_u32 v5, v9, v10
    v_and_b32 v9, 31, v1
    v_lshrrev_b32 v10, 1, v9
    v_and_b32 v10, 7, v10
    v_lshrrev_b32 v11, 5, v1
    s_lshl_b32 s52, s46, 1
    v_xor_b32 v11, s52, v11
    v_xor_b32 v10, v10, v11
    v_lshlrev_b32 v10, 4, v10
    s_lshl_b32 s52, s41, 5
    v_add_u32 v9, s52, v9
    v_lshlrev_b32 v9, 7, v9
    v_add_u32 v9, v9, v10
    v_add_u32 v9, 65536, v9
    v_mov_b32 v98, v9
    v_xor_b32 v99, 32, v9
    v_xor_b32 v100, 64, v9
    v_xor_b32 v101, 96, v9
    v_and_b32 v9, 15, v1
    v_lshrrev_b32 v10, 4, v1
    v_and_b32 v10, 1, v10
    v_lshlrev_b32 v10, 2, v10
    v_cmp_eq_u32 vcc, v9, v10
    v_mov_b32 v11, 0x3f803f80
    v_and_b32 v9, 31, v1
    v_cndmask_b32 v36, 0, v11, vcc
    s_lshl_b32 s52, s42, 6
    v_add_u32 v9, s52, v9
    v_mov_b32 v37, v36
    v_lshlrev_b32 v9, 4, v9
    v_mov_b32 v38, v36
    v_add_u32 v14, 147456, v9
    v_mov_b32 v39, v36
    s_lshl_b32 s52, s41, 2
    v_add_u32 v15, s52, v14
    v_mov_b32 v10, 149504
    v_cmp_gt_u32 vcc, 32, v1
    s_nop 1
    v_cndmask_b32 v15, v10, v15, vcc
    v_lshrrev_b32 v9, 2, v1
    v_and_b32 v9, 3, v9
    v_and_b32 v13, 3, v1
    v_lshlrev_b32 v13, 3, v13
    v_lshrrev_b32 v10, 4, v1
    v_and_b32 v10, 1, v10
    v_lshrrev_b32 v11, 5, v1
    v_lshlrev_b32 v11, 11, v11
    v_add_u32 v13, v13, v11
    v_lshlrev_b32 v11, 5, v10
    v_add_u32 v13, v13, v11
    v_lshlrev_b32 v11, 7, v9
    v_add_u32 v13, v13, v11
    v_lshrrev_b32 v9, 1, v9
    v_xor_b32 v9, s42, v9
    v_lshlrev_b32 v9, 6, v9
    v_add_u32 v13, v13, v9
    s_lshl_b32 s55, s46, 12
    v_add_u32 v13, s55, v13
    v_xor_b32 v24, 0, v13
    v_xor_b32 v25, 4096, v13
    v_xor_b32 v26, 8192, v13
    v_xor_b32 v27, 12288, v13
    v_xor_b32 v28, 1024, v13
    v_xor_b32 v29, 5120, v13
    v_xor_b32 v30, 9216, v13
    v_xor_b32 v31, 13312, v13
    s_waitcnt vmcnt(5)
    s_waitcnt lgkmcnt(0)
    s_barrier
    ds_read_b128 v[128:131], v98 offset:0
    ds_read_b64_tr_b16 v[48:49], v24 offset:0
    ds_read_b64_tr_b16 v[50:51], v24 offset:512
    ds_read_b64_tr_b16 v[52:53], v28 offset:0
    ds_read_b64_tr_b16 v[54:55], v28 offset:512
    ds_read_b128 v[132:135], v99 offset:0
    ds_read_b64_tr_b16 v[56:57], v25 offset:0
    ds_read_b64_tr_b16 v[58:59], v25 offset:512
    s_waitcnt lgkmcnt(5)
    v_mfma_f32_16x16x32_bf16 v[40:43], v[36:39], v[48:51], 0
    v_mfma_f32_32x32x16_bf16 v[64:79], v[128:131], v[48:51], 0
    s_add_u32 m0, s63, 98304
    s_add_u32 s77, s47, 256
    buffer_load_dwordx4 v96, s[4:7], s77 offen lds
    s_add_u32 s77, s47, 7424
    v_mov_b32 v9, 0
    buffer_load_dword v120, v9, s[36:39], 0 offen sc1
    s_cmp_lg_u32 s40, 6
    s_cbranch_scc1 L_cpf_B
    s_lshr_b32 s54, s2, 3
    s_mul_i32 s54, s54, 14
    v_add_u32 v9, s54, v1
    v_lshlrev_b32 v9, 7, v9
    v_cmp_gt_u32 vcc, 14, v1
    s_mov_b64 s[68:69], exec
    s_and_b64 exec, exec, vcc
    v_min_u32 v9, L_end-parallel_sum__linear_attn_block__glu_gated_swiglu__prompt_kernel-512, v9
    global_load_dword v41, v9, s[98:99]
    s_mov_b64 exec, s[68:69]
L_cpf_B:
    ds_read_b64_tr_b16 v[60:61], v29 offset:0
    ds_read_b64_tr_b16 v[62:63], v29 offset:512
    s_waitcnt lgkmcnt(5)
    s_nop 0
    v_mfma_f32_16x16x32_bf16 v[44:47], v[36:39], v[52:55], 0
    v_mfma_f32_32x32x16_bf16 v[80:95], v[128:131], v[52:55], 0
    buffer_load_dwordx4 v97, s[4:7], s77 offen offset:1024 lds
    s_add_u32 m0, s63, 32768
    s_add_u32 s77, s48, 393216
    buffer_load_dwordx4 v3, s[8:11], s77 offen lds
    s_waitcnt vmcnt(4)
    v_lshlrev_b32 v108, 16, v104
    v_and_b32 v109, 0xffff0000, v104
    v_add_f32 v112, v108, v109
    v_mul_f32 v113, v108, v108
    ds_read_b128 v[136:139], v100 offset:0
    ds_read_b64_tr_b16 v[48:49], v26 offset:0
    ds_read_b64_tr_b16 v[50:51], v26 offset:512
    s_waitcnt lgkmcnt(5)
    v_mfma_f32_32x32x16_bf16 v[64:79], v[132:135], v[56:59], v[64:79]
    buffer_load_dwordx4 v3, s[8:11], s77 offen offset:1024 lds
    s_add_u32 m0, s63, 114688
    s_add_u32 s77, s47, 384
    buffer_load_dwordx4 v96, s[4:7], s77 offen lds
    v_fmac_f32 v113, v109, v109
    v_lshlrev_b32 v110, 16, v105
    v_and_b32 v111, 0xffff0000, v105
    v_add_f32 v112, v112, v110
    ds_read_b64_tr_b16 v[52:53], v30 offset:0
    ds_read_b64_tr_b16 v[54:55], v30 offset:512
    s_waitcnt lgkmcnt(5)
    v_mfma_f32_32x32x16_bf16 v[80:95], v[132:135], v[60:63], v[80:95]
    s_add_u32 s77, s47, 7552
    buffer_load_dwordx4 v97, s[4:7], s77 offen offset:1024 lds
    s_add_u32 m0, s63, 49152
    s_add_u32 s77, s48, 589824
    v_fmac_f32 v113, v110, v110
    v_add_f32 v112, v112, v111
    v_fmac_f32 v113, v111, v111
    v_lshlrev_b32 v108, 16, v106
    ds_read_b128 v[140:143], v101 offset:0
    ds_read_b64_tr_b16 v[56:57], v27 offset:0
    ds_read_b64_tr_b16 v[58:59], v27 offset:512
    s_waitcnt lgkmcnt(5)
    v_mfma_f32_32x32x16_bf16 v[64:79], v[136:139], v[48:51], v[64:79]
    buffer_load_dwordx4 v3, s[8:11], s77 offen lds
    buffer_load_dwordx4 v3, s[8:11], s77 offen offset:1024 lds
    s_cmp_lg_u32 s40, 4
    s_cbranch_scc1 L_pw_B_4
    v_mul_u32_u24 v12, 3072, v1
    s_and_b32 s49, s43, 7
    s_lshl_b32 s49, s49, 3
    s_add_u32 s49, s49, 256
    s_mul_i32 s49, s49, 3072
    s_lshl_b32 s3, s45, 7
    s_add_u32 s49, s49, s3
    s_mov_b64 exec, 0xff
    buffer_load_dword v41, v12, s[8:11], s49 offen offset:1024
    buffer_load_dword v41, v12, s[8:11], s49 offen offset:2048
    s_mov_b64 exec, -1
L_pw_B_4:
    v_and_b32 v109, 0xffff0000, v106
    v_add_f32 v112, v112, v108
    v_fmac_f32 v113, v108, v108
    v_add_f32 v112, v112, v109
    ds_read_b64_tr_b16 v[60:61], v31 offset:0
    ds_read_b64_tr_b16 v[62:63], v31 offset:512
    s_waitcnt lgkmcnt(5)
    v_mfma_f32_32x32x16_bf16 v[80:95], v[136:139], v[52:55], v[80:95]
    s_cmp_lg_u32 s40, 0
    s_cbranch_scc1 L_px_B_4
    v_lshlrev_b32 v12, 10, v1
    s_and_b32 s49, s44, 3
    s_lshl_b32 s49, s49, 15
    s_lshl_b32 s3, s43, 17
    s_add_u32 s49, s49, s3
    s_add_u32 s49, s49, 512
    s_mov_b32 exec_hi, 0
    buffer_load_dword v41, v12, s[4:7], s49 offen
    s_mov_b64 exec, -1
L_px_B_4:
    s_cmp_lg_u32 s40, 5
    s_cbranch_scc1 L_pw_B_5
    v_mul_u32_u24 v12, 3072, v1
    s_and_b32 s49, s43, 7
    s_lshl_b32 s49, s49, 3
    s_add_u32 s49, s49, 320
    s_mul_i32 s49, s49, 3072
    s_lshl_b32 s3, s45, 7
    s_add_u32 s49, s49, s3
    s_mov_b64 exec, 0xff
    buffer_load_dword v41, v12, s[8:11], s49 offen offset:1024
    buffer_load_dword v41, v12, s[8:11], s49 offen offset:2048
    s_mov_b64 exec, -1
L_pw_B_5:
    s_cmp_lg_u32 s40, 1
    s_cbranch_scc1 L_px_B_5
    v_lshlrev_b32 v12, 10, v1
    s_and_b32 s49, s44, 3
    s_lshl_b32 s49, s49, 15
    s_lshl_b32 s3, s43, 17
    s_add_u32 s49, s49, s3
    s_add_u32 s49, s49, 640
    s_mov_b32 exec_hi, 0
    buffer_load_dword v41, v12, s[4:7], s49 offen
    s_mov_b64 exec, -1
L_px_B_5:
    s_barrier
    ds_read_b128 v[144:147], v98 offset:16384
    ds_read_b64_tr_b16 v[48:49], v24 offset:16384
    ds_read_b64_tr_b16 v[50:51], v24 offset:16896
    s_waitcnt lgkmcnt(5)
    v_mfma_f32_32x32x16_bf16 v[64:79], v[140:143], v[56:59], v[64:79]
    s_cmp_lg_u32 s40, 6
    s_cbranch_scc1 L_pw_B_6
    v_mul_u32_u24 v12, 3072, v1
    s_and_b32 s49, s43, 7
    s_lshl_b32 s49, s49, 3
    s_add_u32 s49, s49, 384
    s_mul_i32 s49, s49, 3072
    s_lshl_b32 s3, s45, 7
    s_add_u32 s49, s49, s3
    s_mov_b64 exec, 0xff
    buffer_load_dword v41, v12, s[8:11], s49 offen offset:1024
    buffer_load_dword v41, v12, s[8:11], s49 offen offset:2048
    s_mov_b64 exec, -1
L_pw_B_6:
    v_fmac_f32 v113, v109, v109
    v_lshlrev_b32 v110, 16, v107
    v_and_b32 v111, 0xffff0000, v107
    v_add_f32 v112, v112, v110
    ds_read_b64_tr_b16 v[52:53], v28 offset:16384
    ds_read_b64_tr_b16 v[54:55], v28 offset:16896
    s_waitcnt lgkmcnt(5)
    v_mfma_f32_32x32x16_bf16 v[80:95], v[140:143], v[60:63], v[80:95]
    s_cmp_lg_u32 s40, 2
    s_cbranch_scc1 L_px_B_6
    v_lshlrev_b32 v12, 10, v1
    s_and_b32 s49, s44, 3
    s_lshl_b32 s49, s49, 15
    s_lshl_b32 s3, s43, 17
    s_add_u32 s49, s49, s3
    s_add_u32 s49, s49, 768
    s_mov_b32 exec_hi, 0
    buffer_load_dword v41, v12, s[4:7], s49 offen
    s_mov_b64 exec, -1
L_px_B_6:
    v_fmac_f32 v113, v110, v110
    v_add_f32 v112, v112, v111
    v_fmac_f32 v113, v111, v111
    s_nop 0
    v_add_f32_dpp v112, v112, v112 quad_perm:[1,0,3,2] row_mask:0xf bank_mask:0xf
    ds_read_b128 v[148:151], v99 offset:16384
    ds_read_b64_tr_b16 v[56:57], v25 offset:16384
    ds_read_b64_tr_b16 v[58:59], v25 offset:16896
    s_waitcnt lgkmcnt(5)
    v_mfma_f32_16x16x32_bf16 v[40:43], v[36:39], v[48:51], v[40:43]
    v_mfma_f32_32x32x16_bf16 v[64:79], v[144:147], v[48:51], v[64:79]
    v_add_f32_dpp v113, v113, v113 quad_perm:[1,0,3,2] row_mask:0xf bank_mask:0xf
    v_add_f32_dpp v112, v112, v112 quad_perm:[2,3,0,1] row_mask:0xf bank_mask:0xf
    s_nop 0
    v_add_f32_dpp v113, v113, v113 quad_perm:[2,3,0,1] row_mask:0xf bank_mask:0xf
    v_add_f32_dpp v112, v112, v112 row_half_mirror row_mask:0xf bank_mask:0xf
    ds_read_b64_tr_b16 v[60:61], v29 offset:16384
    ds_read_b64_tr_b16 v[62:63], v29 offset:16896
    s_waitcnt lgkmcnt(5)
    v_mfma_f32_16x16x32_bf16 v[44:47], v[36:39], v[52:55], v[44:47]
    v_mfma_f32_32x32x16_bf16 v[80:95], v[144:147], v[52:55], v[80:95]
    v_add_f32_dpp v113, v113, v113 row_half_mirror row_mask:0xf bank_mask:0xf
    v_add_f32_dpp v112, v112, v112 row_mirror row_mask:0xf bank_mask:0xf
    s_nop 0
    v_add_f32_dpp v113, v113, v113 row_mirror row_mask:0xf bank_mask:0xf
    v_mov_b32 v108, v112
    ds_read_b128 v[152:155], v100 offset:16384
    ds_read_b64_tr_b16 v[48:49], v26 offset:16384
    ds_read_b64_tr_b16 v[50:51], v26 offset:16896
    s_waitcnt lgkmcnt(5)
    v_mfma_f32_32x32x16_bf16 v[64:79], v[148:151], v[56:59], v[64:79]
    v_mov_b32 v109, v113
    v_permlane16_swap_b32 v112, v108
    s_nop 0
    v_permlane16_swap_b32 v113, v109
    v_add_f32 v112, v112, v108
    ds_read_b64_tr_b16 v[52:53], v30 offset:16384
    ds_read_b64_tr_b16 v[54:55], v30 offset:16896
    s_waitcnt lgkmcnt(5)
    v_mfma_f32_32x32x16_bf16 v[80:95], v[148:151], v[60:63], v[80:95]
    v_add_f32 v113, v113, v109
    v_mov_b32 v108, v112
    v_mov_b32 v109, v113
    s_nop 0
    v_permlane32_swap_b32 v112, v108
    ds_read_b128 v[156:159], v101 offset:16384
    ds_read_b64_tr_b16 v[56:57], v27 offset:16384
    ds_read_b64_tr_b16 v[58:59], v27 offset:16896
    s_waitcnt lgkmcnt(5)
    v_mfma_f32_32x32x16_bf16 v[64:79], v[152:155], v[48:51], v[64:79]
    v_permlane32_swap_b32 v113, v109
    v_add_f32 v112, v112, v108
    v_add_f32 v113, v113, v109
    v_mul_f32 v104, 0x3b000000, v112
    ds_read_b64_tr_b16 v[60:61], v31 offset:16384
    ds_read_b64_tr_b16 v[62:63], v31 offset:16896
    s_waitcnt lgkmcnt(5)
    v_mfma_f32_32x32x16_bf16 v[80:95], v[152:155], v[52:55], v[80:95]
    s_waitcnt vmcnt(4)
    s_barrier
    ds_read_b128 v[160:163], v98 offset:32768
    ds_read_b64_tr_b16 v[48:49], v24 offset:32768
    ds_read_b64_tr_b16 v[50:51], v24 offset:33280
    s_waitcnt lgkmcnt(5)
    v_mfma_f32_32x32x16_bf16 v[64:79], v[156:159], v[56:59], v[64:79]
    s_add_u32 m0, s63, 0
    s_add_u32 s77, s48, 786432
    v_mul_f32 v113, 0x3b000000, v113
    v_fma_f32 v113, -v104, v104, v113
    v_max_f32 v113, 0, v113
    v_add_f32 v107, 0x3727c5ac, v113
    ds_read_b64_tr_b16 v[52:53], v28 offset:32768
    ds_read_b64_tr_b16 v[54:55], v28 offset:33280
    s_waitcnt lgkmcnt(5)
    v_mfma_f32_32x32x16_bf16 v[80:95], v[156:159], v[60:63], v[80:95]
    buffer_load_dwordx4 v3, s[8:11], s77 offen lds
    v_rsq_f32 v105, v107
    v_mov_b32 v108, 2130706432
    v_cmp_eq_u32 vcc, 0, v1
    ds_read_b128 v[164:167], v99 offset:32768
    ds_read_b64_tr_b16 v[56:57], v25 offset:32768
    ds_read_b64_tr_b16 v[58:59], v25 offset:33280
    s_waitcnt lgkmcnt(5)
    v_mfma_f32_16x16x32_bf16 v[40:43], v[36:39], v[48:51], v[40:43]
    v_mfma_f32_32x32x16_bf16 v[64:79], v[160:163], v[48:51], v[64:79]
    buffer_load_dwordx4 v3, s[8:11], s77 offen offset:1024 lds
    v_mov_b32 v109, 0
    v_cndmask_b32 v110, v108, v109, vcc
    s_memrealtime s[74:75]
    v_readfirstlane_b32 s51, v120
    ds_read_b64_tr_b16 v[60:61], v29 offset:32768
    ds_read_b64_tr_b16 v[62:63], v29 offset:33280
    s_waitcnt lgkmcnt(0)
    v_mfma_f32_16x16x32_bf16 v[44:47], v[36:39], v[52:55], v[44:47]
    v_mfma_f32_32x32x16_bf16 v[80:95], v[160:163], v[52:55], v[80:95]
    s_add_u32 m0, s63, 65536
    s_add_u32 s77, s47, 512
    s_mov_b32 s72, 0
    s_waitcnt lgkmcnt(0)
    s_sub_u32 s55, s74, s51
    s_add_u32 s55, s55, 0x100
    s_cmp_eq_u32 s51, 0
    s_cselect_b32 s55, -1, s55
    s_cmp_lt_u32 s55, 0x20000
    s_cbranch_scc1 L_nok_B
L_nloop_B:
    v_mov_b32 v9, 0
    buffer_load_dword v120, v9, s[36:39], 0 offen sc1
    s_waitcnt vmcnt(0)
    s_memrealtime s[74:75]
    v_readfirstlane_b32 s51, v120
    s_add_u32 s72, s72, 1
    s_waitcnt lgkmcnt(0)
    s_cmp_gt_u32 s72, 0x40000
    s_cbranch_scc1 L_nok_B
    s_sub_u32 s55, s74, s51
    s_add_u32 s55, s55, 0x100
    s_cmp_eq_u32 s51, 0
    s_cselect_b32 s55, -1, s55
    s_cmp_lt_u32 s55, 0x20000
    s_cbranch_scc1 L_nok_B
    s_sleep 2
    s_branch L_nloop_B
L_nok_B:
    ds_read_b128 v[168:171], v100 offset:32768
    ds_read_b64_tr_b16 v[48:49], v26 offset:32768
    ds_read_b64_tr_b16 v[50:51], v26 offset:33280
    v_mfma_f32_32x32x16_bf16 v[64:79], v[164:167], v[56:59], v[64:79]
    buffer_load_dwordx4 v96, s[4:7], s77 offen lds
    v_mov_b32 v106, s51
    s_lshl_b32 s54, s43, 7
    s_lshl_b32 s55, s44, 3
    s_add_u32 s54, s54, s55
    s_add_u32 s54, s54, s40
    s_lshl_b32 s54, s54, 4
    s_add_u32 s54, s54, 12599296
    ds_read_b64_tr_b16 v[52:53], v30 offset:32768
    ds_read_b64_tr_b16 v[54:55], v30 offset:33280
    v_mfma_f32_32x32x16_bf16 v[80:95], v[164:167], v[60:63], v[80:95]
    s_add_u32 s77, s47, 7680
    buffer_load_dwordx4 v97, s[4:7], s77 offen offset:1024 lds
    buffer_store_dwordx4 v[104:107], v110, s[32:35], s54 offen sc1
    ds_read_b128 v[172:175], v101 offset:32768
    ds_read_b64_tr_b16 v[56:57], v27 offset:32768
    ds_read_b64_tr_b16 v[58:59], v27 offset:33280
    s_waitcnt lgkmcnt(5)
    v_mfma_f32_32x32x16_bf16 v[64:79], v[168:171], v[48:51], v[64:79]
    s_cmp_lg_u32 s40, 7
    s_cbranch_scc1 L_pw_B_7
    v_mul_u32_u24 v12, 3072, v1
    s_and_b32 s49, s43, 7
    s_lshl_b32 s49, s49, 3
    s_add_u32 s49, s49, 448
    s_mul_i32 s49, s49, 3072
    s_lshl_b32 s3, s45, 7
    s_add_u32 s49, s49, s3
    s_mov_b64 exec, 0xff
    buffer_load_dword v41, v12, s[8:11], s49 offen offset:1024
    buffer_load_dword v41, v12, s[8:11], s49 offen offset:2048
    s_mov_b64 exec, -1
L_pw_B_7:
    ds_read_b64_tr_b16 v[60:61], v31 offset:32768
    ds_read_b64_tr_b16 v[62:63], v31 offset:33280
    s_waitcnt lgkmcnt(5)
    s_nop 0
    v_mfma_f32_32x32x16_bf16 v[80:95], v[168:171], v[52:55], v[80:95]
    s_cmp_lg_u32 s40, 3
    s_cbranch_scc1 L_px_B_7
    v_lshlrev_b32 v12, 10, v1
    s_and_b32 s49, s44, 3
    s_lshl_b32 s49, s49, 15
    s_lshl_b32 s3, s43, 17
    s_add_u32 s49, s49, s3
    s_add_u32 s49, s49, 896
    s_mov_b32 exec_hi, 0
    buffer_load_dword v41, v12, s[4:7], s49 offen
    s_mov_b64 exec, -1
L_px_B_7:
    s_waitcnt vmcnt(5)
    s_barrier
    ds_read_b128 v[176:179], v98 offset:49152
    ds_read_b64_tr_b16 v[48:49], v24 offset:49152
    ds_read_b64_tr_b16 v[50:51], v24 offset:49664
    s_waitcnt lgkmcnt(5)
    v_mfma_f32_32x32x16_bf16 v[64:79], v[172:175], v[56:59], v[64:79]
    s_add_u32 m0, s63, 16384
    s_add_u32 s77, s48, 983040
    ds_read_b64_tr_b16 v[52:53], v28 offset:49152
    ds_read_b64_tr_b16 v[54:55], v28 offset:49664
    s_waitcnt lgkmcnt(5)
    v_mfma_f32_32x32x16_bf16 v[80:95], v[172:175], v[60:63], v[80:95]
    buffer_load_dwordx4 v3, s[8:11], s77 offen lds
    ds_read_b128 v[180:183], v99 offset:49152
    ds_read_b64_tr_b16 v[56:57], v25 offset:49152
    ds_read_b64_tr_b16 v[58:59], v25 offset:49664
    s_waitcnt lgkmcnt(5)
    v_mfma_f32_16x16x32_bf16 v[40:43], v[36:39], v[48:51], v[40:43]
    v_mfma_f32_32x32x16_bf16 v[64:79], v[176:179], v[48:51], v[64:79]
    buffer_load_dwordx4 v3, s[8:11], s77 offen offset:1024 lds
    ds_read_b64_tr_b16 v[60:61], v29 offset:49152
    ds_read_b64_tr_b16 v[62:63], v29 offset:49664
    s_waitcnt lgkmcnt(5)
    v_mfma_f32_16x16x32_bf16 v[44:47], v[36:39], v[52:55], v[44:47]
    v_mfma_f32_32x32x16_bf16 v[80:95], v[176:179], v[52:55], v[80:95]
    s_add_u32 m0, s63, 81920
    s_add_u32 s77, s47, 640
    ds_read_b128 v[184:187], v100 offset:49152
    ds_read_b64_tr_b16 v[48:49], v26 offset:49152
    ds_read_b64_tr_b16 v[50:51], v26 offset:49664
    s_waitcnt lgkmcnt(5)
    v_mfma_f32_32x32x16_bf16 v[64:79], v[180:183], v[56:59], v[64:79]
    buffer_load_dwordx4 v96, s[4:7], s77 offen lds
    ds_read_b64_tr_b16 v[52:53], v30 offset:49152
    ds_read_b64_tr_b16 v[54:55], v30 offset:49664
    s_waitcnt lgkmcnt(5)
    v_mfma_f32_32x32x16_bf16 v[80:95], v[180:183], v[60:63], v[80:95]
    s_add_u32 s77, s47, 7808
    buffer_load_dwordx4 v97, s[4:7], s77 offen offset:1024 lds
    ds_read_b128 v[188:191], v101 offset:49152
    ds_read_b64_tr_b16 v[56:57], v27 offset:49152
    ds_read_b64_tr_b16 v[58:59], v27 offset:49664
    s_waitcnt lgkmcnt(5)
    v_mfma_f32_32x32x16_bf16 v[64:79], v[184:187], v[48:51], v[64:79]
    s_cmp_lg_u32 s40, 0
    s_cbranch_scc1 L_pw_B_8
    v_mul_u32_u24 v12, 3584, v1
    s_and_b32 s49, s43, 7
    s_lshl_b32 s49, s49, 3
    s_add_u32 s49, s49, 0
    s_mul_i32 s49, s49, 3584
    s_lshl_b32 s3, s62, 1
    s_add_u32 s49, s49, s3
    s_mov_b64 exec, 0xff
    buffer_load_dword v41, v12, s[12:15], s49 offen
    buffer_load_dword v41, v12, s[16:19], s49 offen offset:1024
    s_mov_b64 exec, -1
L_pw_B_8:
    ds_read_b64_tr_b16 v[60:61], v31 offset:49152
    ds_read_b64_tr_b16 v[62:63], v31 offset:49664
    s_waitcnt lgkmcnt(5)
    s_nop 0
    v_mfma_f32_32x32x16_bf16 v[80:95], v[184:187], v[52:55], v[80:95]
    s_add_u32 m0, s67, 131072
    s_add_u32 s77, s58, 0
    buffer_load_dwordx4 v5, s[20:23], s77 offen lds
    s_add_u32 s77, s58, 7168
    buffer_load_dwordx4 v5, s[20:23], s77 offen offset:1024 lds
    s_waitcnt vmcnt(7)
    s_barrier
    ds_read_b128 v[192:195], v98 offset:0
    ds_read_b64_tr_b16 v[48:49], v24 offset:0
    ds_read_b64_tr_b16 v[50:51], v24 offset:512
    s_waitcnt lgkmcnt(5)
    v_mfma_f32_32x32x16_bf16 v[64:79], v[188:191], v[56:59], v[64:79]
    s_add_u32 m0, s63, 32768
    s_add_u32 s77, s48, 1179648
    ds_read_b64_tr_b16 v[52:53], v28 offset:0
    ds_read_b64_tr_b16 v[54:55], v28 offset:512
    s_waitcnt lgkmcnt(5)
    v_mfma_f32_32x32x16_bf16 v[80:95], v[188:191], v[60:63], v[80:95]
    buffer_load_dwordx4 v3, s[8:11], s77 offen lds
    ds_read_b128 v[196:199], v99 offset:0
    ds_read_b64_tr_b16 v[56:57], v25 offset:0
    ds_read_b64_tr_b16 v[58:59], v25 offset:512
    s_waitcnt lgkmcnt(5)
    v_mfma_f32_16x16x32_bf16 v[40:43], v[36:39], v[48:51], v[40:43]
    v_mfma_f32_32x32x16_bf16 v[64:79], v[192:195], v[48:51], v[64:79]
    buffer_load_dwordx4 v3, s[8:11], s77 offen offset:1024 lds
    ds_read_b64_tr_b16 v[60:61], v29 offset:0
    ds_read_b64_tr_b16 v[62:63], v29 offset:512
    s_waitcnt lgkmcnt(5)
    v_mfma_f32_16x16x32_bf16 v[44:47], v[36:39], v[52:55], v[44:47]
    v_mfma_f32_32x32x16_bf16 v[80:95], v[192:195], v[52:55], v[80:95]
    s_add_u32 m0, s63, 98304
    s_add_u32 s77, s47, 768
    ds_read_b128 v[200:203], v100 offset:0
    ds_read_b64_tr_b16 v[48:49], v26 offset:0
    ds_read_b64_tr_b16 v[50:51], v26 offset:512
    s_waitcnt lgkmcnt(5)
    v_mfma_f32_32x32x16_bf16 v[64:79], v[196:199], v[56:59], v[64:79]
    buffer_load_dwordx4 v96, s[4:7], s77 offen lds
    ds_read_b64_tr_b16 v[52:53], v30 offset:0
    ds_read_b64_tr_b16 v[54:55], v30 offset:512
    s_waitcnt lgkmcnt(5)
    v_mfma_f32_32x32x16_bf16 v[80:95], v[196:199], v[60:63], v[80:95]
    s_add_u32 s77, s47, 7936
    buffer_load_dwordx4 v97, s[4:7], s77 offen offset:1024 lds
    ds_read_b128 v[204:207], v101 offset:0
    ds_read_b64_tr_b16 v[56:57], v27 offset:0
    ds_read_b64_tr_b16 v[58:59], v27 offset:512
    s_waitcnt lgkmcnt(5)
    v_mfma_f32_32x32x16_bf16 v[64:79], v[200:203], v[48:51], v[64:79]
    s_cmp_lg_u32 s40, 1
    s_cbranch_scc1 L_pw_B_9
    v_mul_u32_u24 v12, 3584, v1
    s_and_b32 s49, s43, 7
    s_lshl_b32 s49, s49, 3
    s_add_u32 s49, s49, 64
    s_mul_i32 s49, s49, 3584
    s_lshl_b32 s3, s62, 1
    s_add_u32 s49, s49, s3
    s_mov_b64 exec, 0xff
    buffer_load_dword v41, v12, s[12:15], s49 offen
    buffer_load_dword v41, v12, s[16:19], s49 offen offset:1024
    s_mov_b64 exec, -1
L_pw_B_9:
    ds_read_b64_tr_b16 v[60:61], v31 offset:0
    ds_read_b64_tr_b16 v[62:63], v31 offset:512
    s_waitcnt lgkmcnt(5)
    s_nop 0
    v_mfma_f32_32x32x16_bf16 v[80:95], v[200:203], v[52:55], v[80:95]
    s_waitcnt vmcnt(6)
    s_barrier
    ds_read_b128 v[208:211], v98 offset:16384
    ds_read_b64_tr_b16 v[48:49], v24 offset:16384
    ds_read_b64_tr_b16 v[50:51], v24 offset:16896
    s_waitcnt lgkmcnt(5)
    v_mfma_f32_32x32x16_bf16 v[64:79], v[204:207], v[56:59], v[64:79]
    s_add_u32 m0, s63, 49152
    s_add_u32 s77, s48, 1376256
    ds_read_b64_tr_b16 v[52:53], v28 offset:16384
    ds_read_b64_tr_b16 v[54:55], v28 offset:16896
    s_waitcnt lgkmcnt(5)
    v_mfma_f32_32x32x16_bf16 v[80:95], v[204:207], v[60:63], v[80:95]
    buffer_load_dwordx4 v3, s[8:11], s77 offen lds
    ds_read_b128 v[212:215], v99 offset:16384
    ds_read_b64_tr_b16 v[56:57], v25 offset:16384
    ds_read_b64_tr_b16 v[58:59], v25 offset:16896
    s_waitcnt lgkmcnt(5)
    v_mfma_f32_16x16x32_bf16 v[40:43], v[36:39], v[48:51], v[40:43]
    v_mfma_f32_32x32x16_bf16 v[64:79], v[208:211], v[48:51], v[64:79]
    buffer_load_dwordx4 v3, s[8:11], s77 offen offset:1024 lds
    ds_read_b64_tr_b16 v[60:61], v29 offset:16384
    ds_read_b64_tr_b16 v[62:63], v29 offset:16896
    s_waitcnt lgkmcnt(5)
    v_mfma_f32_16x16x32_bf16 v[44:47], v[36:39], v[52:55], v[44:47]
    v_mfma_f32_32x32x16_bf16 v[80:95], v[208:211], v[52:55], v[80:95]
    s_add_u32 m0, s63, 114688
    s_add_u32 s77, s47, 896
    ds_read_b128 v[216:219], v100 offset:16384
    ds_read_b64_tr_b16 v[48:49], v26 offset:16384
    ds_read_b64_tr_b16 v[50:51], v26 offset:16896
    s_waitcnt lgkmcnt(5)
    v_mfma_f32_32x32x16_bf16 v[64:79], v[212:215], v[56:59], v[64:79]
    buffer_load_dwordx4 v96, s[4:7], s77 offen lds
    ds_read_b64_tr_b16 v[52:53], v30 offset:16384
    ds_read_b64_tr_b16 v[54:55], v30 offset:16896
    s_waitcnt lgkmcnt(5)
    v_mfma_f32_32x32x16_bf16 v[80:95], v[212:215], v[60:63], v[80:95]
    s_add_u32 s77, s47, 8064
    buffer_load_dwordx4 v97, s[4:7], s77 offen offset:1024 lds
    ds_read_b128 v[220:223], v101 offset:16384
    ds_read_b64_tr_b16 v[56:57], v27 offset:16384
    ds_read_b64_tr_b16 v[58:59], v27 offset:16896
    s_waitcnt lgkmcnt(5)
    v_mfma_f32_32x32x16_bf16 v[64:79], v[216:219], v[48:51], v[64:79]
    s_cmp_lg_u32 s40, 2
    s_cbranch_scc1 L_pw_B_10
    v_mul_u32_u24 v12, 3584, v1
    s_and_b32 s49, s43, 7
    s_lshl_b32 s49, s49, 3
    s_add_u32 s49, s49, 128
    s_mul_i32 s49, s49, 3584
    s_lshl_b32 s3, s62, 1
    s_add_u32 s49, s49, s3
    s_mov_b64 exec, 0xff
    buffer_load_dword v41, v12, s[12:15], s49 offen
    buffer_load_dword v41, v12, s[16:19], s49 offen offset:1024
    s_mov_b64 exec, -1
L_pw_B_10:
    ds_read_b64_tr_b16 v[60:61], v31 offset:16384
    ds_read_b64_tr_b16 v[62:63], v31 offset:16896
    s_waitcnt lgkmcnt(5)
    s_nop 0
    v_mfma_f32_32x32x16_bf16 v[80:95], v[216:219], v[52:55], v[80:95]
    s_waitcnt vmcnt(4)
    s_barrier
    ds_read_b128 v[224:227], v98 offset:32768
    ds_read_b64_tr_b16 v[48:49], v24 offset:32768
    ds_read_b64_tr_b16 v[50:51], v24 offset:33280
    s_waitcnt lgkmcnt(5)
    v_mfma_f32_32x32x16_bf16 v[64:79], v[220:223], v[56:59], v[64:79]
    v_lshrrev_b32 v3, 3, v1
    v_lshrrev_b32 v9, 2, v1
    v_and_b32 v9, 3, v9
    v_and_b32 v13, 3, v1
    v_lshlrev_b32 v13, 3, v13
    ds_read_b64_tr_b16 v[52:53], v28 offset:32768
    ds_read_b64_tr_b16 v[54:55], v28 offset:33280
    s_waitcnt lgkmcnt(5)
    v_mfma_f32_32x32x16_bf16 v[80:95], v[220:223], v[60:63], v[80:95]
    v_and_b32 v4, 7, v1
    v_lshrrev_b32 v10, 4, v1
    v_and_b32 v10, 1, v10
    v_lshrrev_b32 v11, 5, v1
    v_lshlrev_b32 v11, 11, v11
    ds_read_b128 v[228:231], v99 offset:32768
    ds_read_b64_tr_b16 v[56:57], v25 offset:32768
    ds_read_b64_tr_b16 v[58:59], v25 offset:33280
    s_waitcnt lgkmcnt(5)
    v_mfma_f32_16x16x32_bf16 v[40:43], v[36:39], v[48:51], v[40:43]
    v_mfma_f32_32x32x16_bf16 v[64:79], v[224:227], v[48:51], v[64:79]
    v_and_b32 v12, 2, v3
    v_add_u32 v13, v13, v11
    v_lshlrev_b32 v11, 10, v10
    v_add_u32 v13, v13, v11
    v_lshlrev_b32 v11, 7, v9
    ds_read_b64_tr_b16 v[60:61], v29 offset:32768
    ds_read_b64_tr_b16 v[62:63], v29 offset:33280
    s_waitcnt lgkmcnt(5)
    v_mfma_f32_16x16x32_bf16 v[44:47], v[36:39], v[52:55], v[44:47]
    v_mfma_f32_32x32x16_bf16 v[80:95], v[224:227], v[52:55], v[80:95]
    v_xor_b32 v4, v4, v12
    v_add_u32 v13, v13, v11
    v_lshrrev_b32 v9, 1, v9
    v_lshlrev_b32 v10, 1, v10
    v_or_b32 v9, v9, v10
    ds_read_b128 v[232:235], v100 offset:32768
    ds_read_b64_tr_b16 v[48:49], v26 offset:32768
    ds_read_b64_tr_b16 v[50:51], v26 offset:33280
    s_waitcnt lgkmcnt(5)
    v_mfma_f32_32x32x16_bf16 v[64:79], v[228:231], v[56:59], v[64:79]
    v_lshlrev_b32 v4, 4, v4
    s_lshl_b32 s55, s42, 1
    v_xor_b32 v9, s55, v9
    v_lshlrev_b32 v9, 5, v9
    v_add_u32 v13, v13, v9
    s_lshl_b32 s55, s46, 12
    ds_read_b64_tr_b16 v[52:53], v30 offset:32768
    ds_read_b64_tr_b16 v[54:55], v30 offset:33280
    s_waitcnt lgkmcnt(5)
    v_mfma_f32_32x32x16_bf16 v[80:95], v[228:231], v[60:63], v[80:95]
    v_mul_u32_u24 v3, 3584, v3
    v_add_u32 v13, s55, v13
    v_and_b32 v9, 31, v1
    v_lshlrev_b32 v9, 4, v9
    s_lshl_b32 s54, s43, 7
    s_lshl_b32 s55, s41, 5
    ds_read_b128 v[236:239], v101 offset:32768
    ds_read_b64_tr_b16 v[56:57], v27 offset:32768
    ds_read_b64_tr_b16 v[58:59], v27 offset:33280
    s_waitcnt lgkmcnt(5)
    v_mfma_f32_32x32x16_bf16 v[64:79], v[232:235], v[48:51], v[64:79]
    v_add_u32 v3, v3, v4
    s_add_u32 s54, s54, s55
    s_lshl_b32 s54, s54, 4
    s_add_u32 s54, s54, 12599296
    buffer_load_dwordx4 v[32:35], v9, s[32:35], s54 offen sc1
    ds_read_b64_tr_b16 v[60:61], v31 offset:32768
    ds_read_b64_tr_b16 v[62:63], v31 offset:33280
    s_waitcnt lgkmcnt(5)
    v_mfma_f32_32x32x16_bf16 v[80:95], v[232:235], v[52:55], v[80:95]
    v_xor_b32 v4, 64, v3
    s_mul_i32 s48, s40, 28672
    s_lshl_b32 s77, s62, 1
    s_add_u32 s48, s48, s77
    s_add_u32 m0, s63, 0
    s_add_u32 s77, s48, 0
    buffer_load_dwordx4 v3, s[12:15], s77 offen lds
    buffer_load_dwordx4 v4, s[16:19], s77 offen offset:1024 lds
    s_cmp_lg_u32 s40, 3
    s_cbranch_scc1 L_pw_B_11
    v_mul_u32_u24 v12, 3584, v1
    s_and_b32 s49, s43, 7
    s_lshl_b32 s49, s49, 3
    s_add_u32 s49, s49, 192
    s_mul_i32 s49, s49, 3584
    s_lshl_b32 s3, s62, 1
    s_add_u32 s49, s49, s3
    s_mov_b64 exec, 0xff
    buffer_load_dword v41, v12, s[12:15], s49 offen
    buffer_load_dword v41, v12, s[16:19], s49 offen offset:1024
    s_mov_b64 exec, -1
L_pw_B_11:
    s_waitcnt vmcnt(3)
    s_barrier
    ds_read_b128 v[240:243], v98 offset:49152
    ds_read_b64_tr_b16 v[48:49], v24 offset:49152
    ds_read_b64_tr_b16 v[50:51], v24 offset:49664
    v_xor_b32 v24, 0, v13
    s_waitcnt lgkmcnt(5)
    v_mfma_f32_32x32x16_bf16 v[64:79], v[236:239], v[56:59], v[64:79]
    s_add_u32 m0, s63, 16384
    s_add_u32 s77, s48, 229376
    ds_read_b64_tr_b16 v[52:53], v28 offset:49152
    ds_read_b64_tr_b16 v[54:55], v28 offset:49664
    v_xor_b32 v28, 32, v13
    s_waitcnt lgkmcnt(5)
    v_mfma_f32_32x32x16_bf16 v[80:95], v[236:239], v[60:63], v[80:95]
    buffer_load_dwordx4 v3, s[12:15], s77 offen lds
    ds_read_b128 v[244:247], v99 offset:49152
    ds_read_b64_tr_b16 v[56:57], v25 offset:49152
    ds_read_b64_tr_b16 v[58:59], v25 offset:49664
    v_xor_b32 v25, 4096, v13
    s_waitcnt lgkmcnt(5)
    v_mfma_f32_16x16x32_bf16 v[40:43], v[36:39], v[48:51], v[40:43]
    v_mfma_f32_32x32x16_bf16 v[64:79], v[240:243], v[48:51], v[64:79]
    buffer_load_dwordx4 v4, s[16:19], s77 offen offset:1024 lds
    ds_read_b64_tr_b16 v[60:61], v29 offset:49152
    ds_read_b64_tr_b16 v[62:63], v29 offset:49664
    v_xor_b32 v29, 4128, v13
    s_waitcnt lgkmcnt(5)
    v_mfma_f32_16x16x32_bf16 v[44:47], v[36:39], v[52:55], v[44:47]
    v_mfma_f32_32x32x16_bf16 v[80:95], v[240:243], v[52:55], v[80:95]
    s_cmp_lg_u32 s40, 4
    s_cbranch_scc1 L_pw_B_12
    v_mul_u32_u24 v12, 3584, v1
    s_and_b32 s49, s43, 7
    s_lshl_b32 s49, s49, 3
    s_add_u32 s49, s49, 256
    s_mul_i32 s49, s49, 3584
    s_lshl_b32 s3, s62, 1
    s_add_u32 s49, s49, s3
    s_mov_b64 exec, 0xff
    buffer_load_dword v41, v12, s[12:15], s49 offen
    buffer_load_dword v41, v12, s[16:19], s49 offen offset:1024
    s_mov_b64 exec, -1
L_pw_B_12:
    ds_write_b32 v15, v40 offset:0
    s_nop 3
    ds_write_b32 v15, v44 offset:512
    ds_read_b128 v[248:251], v100 offset:49152
    ds_read_b64_tr_b16 v[48:49], v26 offset:49152
    ds_read_b64_tr_b16 v[50:51], v26 offset:49664
    v_xor_b32 v26, 8192, v13
    s_waitcnt lgkmcnt(7)
    v_mfma_f32_32x32x16_bf16 v[64:79], v[244:247], v[56:59], v[64:79]
    ds_read_b64_tr_b16 v[52:53], v30 offset:49152
    ds_read_b64_tr_b16 v[54:55], v30 offset:49664
    v_xor_b32 v30, 8224, v13
    s_waitcnt lgkmcnt(7)
    v_mfma_f32_32x32x16_bf16 v[80:95], v[244:247], v[60:63], v[80:95]
    ds_read_b128 v[252:255], v101 offset:49152
    ds_read_b64_tr_b16 v[56:57], v27 offset:49152
    ds_read_b64_tr_b16 v[58:59], v27 offset:49664
    v_xor_b32 v27, 12288, v13
    s_waitcnt lgkmcnt(5)
    v_mfma_f32_32x32x16_bf16 v[64:79], v[248:251], v[48:51], v[64:79]
    ds_read_b64_tr_b16 v[60:61], v31 offset:49152
    ds_read_b64_tr_b16 v[62:63], v31 offset:49664
    v_xor_b32 v31, 12320, v13
    s_waitcnt lgkmcnt(5)
    v_mfma_f32_32x32x16_bf16 v[80:95], v[248:251], v[52:55], v[80:95]
    s_waitcnt vmcnt(2)
    s_waitcnt lgkmcnt(0)
    s_barrier
    ds_read_b64_tr_b16 v[48:49], v24 offset:0
    ds_read_b64_tr_b16 v[50:51], v24 offset:512
    v_mfma_f32_32x32x16_bf16 v[64:79], v[252:255], v[56:59], v[64:79]
    s_add_u32 m0, s63, 32768
    s_add_u32 s77, s48, 458752
    v_cmp_eq_u32 vcc, s51, v34
    s_mov_b32 s72, 0
    s_nop 1
    s_cmp_eq_u64 vcc, exec
    s_cbranch_scc1 L_sok_B
    v_and_b32 v9, 31, v1
    v_lshlrev_b32 v9, 4, v9
    s_lshl_b32 s54, s43, 7
    s_lshl_b32 s55, s41, 5
    s_add_u32 s54, s54, s55
    s_lshl_b32 s54, s54, 4
    s_add_u32 s54, s54, 12599296
L_sloop_B:
    buffer_load_dwordx4 v[32:35], v9, s[32:35], s54 offen sc1
    s_waitcnt vmcnt(0)
    v_cmp_eq_u32 vcc, s51, v34
    s_add_u32 s72, s72, 1
    s_cmp_gt_u32 s72, 0x80000
    s_cbranch_scc1 L_sok_B
    s_cmp_eq_u64 vcc, exec
    s_cbranch_scc1 L_sok_B
    s_sleep 4
    s_branch L_sloop_B
L_sok_B:
    ds_read_b64_tr_b16 v[52:53], v28 offset:0
    ds_read_b64_tr_b16 v[54:55], v28 offset:512
    v_mfma_f32_32x32x16_bf16 v[80:95], v[252:255], v[60:63], v[80:95]
    buffer_load_dwordx4 v3, s[12:15], s77 offen lds
    v_and_b32 v22, 31, v1
    s_lshl_b32 s55, s41, 5
    v_add_u32 v22, s55, v22
    v_lshlrev_b32 v22, 2, v22
    v_add_u32 v22, 153600, v22
    ds_read_b64_tr_b16 v[56:57], v25 offset:0
    ds_read_b64_tr_b16 v[58:59], v25 offset:512
    s_waitcnt lgkmcnt(4)
    v_mfma_f32_16x16x32_bf16 v[40:43], v[36:39], v[48:51], 0
    v_mfma_f32_32x32x16_bf16 v[96:111], v[48:51], v[128:131], 0
    buffer_load_dwordx4 v4, s[16:19], s77 offen offset:1024 lds
    v_mov_b32 v8, v33
    v_cvt_pk_bf16_f32 v18, -v32, -v32
    v_mul_f32 v6, 0xbfb8aa3b, v33
    v_mul_f32 v17, v35, v33
    v_mul_f32 v7, 0xbfb8aa3b, v17
    v_and_b32 v19, 0xffff0000, v18
    v_sub_f32 v19, -v32, v19
    ds_read_b64_tr_b16 v[60:61], v29 offset:0
    ds_read_b64_tr_b16 v[62:63], v29 offset:512
    s_waitcnt lgkmcnt(4)
    v_mfma_f32_16x16x32_bf16 v[44:47], v[36:39], v[52:55], 0
    v_mfma_f32_32x32x16_bf16 v[112:127], v[52:55], v[128:131], 0
    s_cmp_lg_u32 s40, 5
    s_cbranch_scc1 L_pw_B_13
    v_mul_u32_u24 v12, 3584, v1
    s_and_b32 s49, s43, 7
    s_lshl_b32 s49, s49, 3
    s_add_u32 s49, s49, 320
    s_mul_i32 s49, s49, 3584
    s_lshl_b32 s3, s62, 1
    s_add_u32 s49, s49, s3
    s_mov_b64 exec, 0xff
    buffer_load_dword v41, v12, s[12:15], s49 offen
    buffer_load_dword v41, v12, s[16:19], s49 offen offset:1024
    s_mov_b64 exec, -1
L_pw_B_13:
    v_cvt_pk_bf16_f32 v33, -v32, 0
    v_cvt_pk_bf16_f32 v32, -v32, v19
    v_cmp_gt_u32 vcc, 32, v1
    v_sub_f32 v20, 0, v6
    s_nop 0
    v_cndmask_b32 v32, 0, v32, vcc
    v_cndmask_b32 v33, 0, v33, vcc
    v_mov_b32 v34, 0
    ds_read_b64_tr_b16 v[48:49], v26 offset:0
    ds_read_b64_tr_b16 v[50:51], v26 offset:512
    s_waitcnt lgkmcnt(4)
    v_mfma_f32_32x32x16_bf16 v[96:111], v[56:59], v[132:135], v[96:111]
    s_cmp_lt_u32 s40, 6
    s_cbranch_scc1 L_mt_B
    v_lshlrev_b32 v12, 7, v1
    s_mov_b64 s[68:69], exec
    s_cmp_eq_u32 s40, 7
    s_cbranch_scc1 L_mt_B_o
    s_mul_i32 s49, s2, 7168
    s_mov_b32 exec_hi, 0x00ffffff
    buffer_load_dword v41, v12, s[20:23], s49 offen
    s_branch L_mt_B_e
L_mt_B_o:
    s_lshl_b32 s49, s2, 11
    s_mov_b64 exec, 0xffff
    buffer_load_dword v41, v12, s[24:27], s49 offen
L_mt_B_e:
    s_mov_b64 exec, s[68:69]
L_mt_B:
    v_mov_b32 v35, 0
    ds_write_b32 v22, v20
    ds_read_b128 v[16:19], v14 offset:0
    s_waitcnt lgkmcnt(0)
    v_add_f32 v16, v16, v17
    v_add_f32 v18, v18, v19
    v_mov_b32 v22, 0
    v_add_f32 v16, v16, v18
    ds_read_b64_tr_b16 v[52:53], v30 offset:0
    ds_read_b64_tr_b16 v[54:55], v30 offset:512
    v_mfma_f32_32x32x16_bf16 v[112:127], v[60:63], v[132:135], v[112:127]
    v_mov_b32 v23, 0
    v_cvt_pk_bf16_f32 v20, v16, v16
    v_and_b32 v17, 0xffff0000, v20
    v_sub_f32 v16, v16, v17
    v_cvt_pk_bf16_f32 v21, v16, 0
    s_nop 1
    v_mfma_f32_32x32x16_bf16 v[64:79], v[32:35], v[20:23], v[64:79]
    ds_read_b64_tr_b16 v[56:57], v27 offset:0
    ds_read_b64_tr_b16 v[58:59], v27 offset:512
    v_mfma_f32_32x32x16_bf16 v[96:111], v[48:51], v[136:139], v[96:111]
    ds_read_b128 v[16:19], v14 offset:512
    s_waitcnt lgkmcnt(0)
    v_add_f32 v16, v16, v17
    v_add_f32 v18, v18, v19
    v_mov_b32 v22, 0
    v_add_f32 v16, v16, v18
    v_mov_b32 v23, 0
    v_cvt_pk_bf16_f32 v20, v16, v16
    ds_read_b64_tr_b16 v[60:61], v31 offset:0
    ds_read_b64_tr_b16 v[62:63], v31 offset:512
    v_mfma_f32_32x32x16_bf16 v[112:127], v[52:55], v[136:139], v[112:127]
    s_waitcnt vmcnt(2)
    s_waitcnt lgkmcnt(0)
    s_barrier
    ds_read_b64_tr_b16 v[48:49], v24 offset:16384
    ds_read_b64_tr_b16 v[50:51], v24 offset:16896
    v_mfma_f32_32x32x16_bf16 v[96:111], v[56:59], v[140:143], v[96:111]
    s_add_u32 m0, s63, 49152
    s_add_u32 s77, s48, 688128
    v_and_b32 v17, 0xffff0000, v20
    v_sub_f32 v16, v16, v17
    v_cvt_pk_bf16_f32 v21, v16, 0
    s_nop 1
    v_mfma_f32_32x32x16_bf16 v[80:95], v[32:35], v[20:23], v[80:95]
    ds_read_b64_tr_b16 v[52:53], v28 offset:16384
    ds_read_b64_tr_b16 v[54:55], v28 offset:16896
    v_mfma_f32_32x32x16_bf16 v[112:127], v[60:63], v[140:143], v[112:127]
    buffer_load_dwordx4 v3, s[12:15], s77 offen lds
    v_mov_b32 v10, 0x3f317218
    v_lshrrev_b32 v9, 5, v1
    v_lshlrev_b32 v9, 4, v9
    s_lshl_b32 s55, s41, 7
    v_add_u32 v9, s55, v9
    v_add_u32 v9, 153600, v9
    ds_read_b128 v[16:19], v9 offset:0
    s_waitcnt lgkmcnt(0)
    v_mul_f32 v64, v64, v16
    ds_read_b64_tr_b16 v[56:57], v25 offset:16384
    ds_read_b64_tr_b16 v[58:59], v25 offset:16896
    v_mfma_f32_16x16x32_bf16 v[40:43], v[36:39], v[48:51], v[40:43]
    v_mfma_f32_32x32x16_bf16 v[96:111], v[48:51], v[144:147], v[96:111]
    buffer_load_dwordx4 v4, s[16:19], s77 offen offset:1024 lds
    v_mul_f32 v65, v65, v17
    v_mul_f32 v66, v66, v18
    v_mul_f32 v67, v67, v19
    v_mul_f32 v80, v80, v16
    v_mul_f32 v81, v81, v17
    v_mul_f32 v82, v82, v18
    v_mul_f32 v83, v83, v19
    ds_read_b64_tr_b16 v[60:61], v29 offset:16384
    ds_read_b64_tr_b16 v[62:63], v29 offset:16896
    v_mfma_f32_16x16x32_bf16 v[44:47], v[36:39], v[52:55], v[44:47]
    v_mfma_f32_32x32x16_bf16 v[112:127], v[52:55], v[144:147], v[112:127]
    s_cmp_lg_u32 s40, 6
    s_cbranch_scc1 L_pw_B_14
    v_mul_u32_u24 v12, 3584, v1
    s_and_b32 s49, s43, 7
    s_lshl_b32 s49, s49, 3
    s_add_u32 s49, s49, 384
    s_mul_i32 s49, s49, 3584
    s_lshl_b32 s3, s62, 1
    s_add_u32 s49, s49, s3
    s_mov_b64 exec, 0xff
    buffer_load_dword v41, v12, s[12:15], s49 offen
    buffer_load_dword v41, v12, s[16:19], s49 offen offset:1024
    s_mov_b64 exec, -1
L_pw_B_14:
    v_min_f32 v20, 0, v64
    v_min_f32 v21, 0, v65
    v_min_f32 v22, 0, v66
    v_min_f32 v23, 0, v67
    v_exp_f32 v20, v20
    v_exp_f32 v21, v21
    ds_read_b64_tr_b16 v[48:49], v26 offset:16384
    ds_read_b64_tr_b16 v[50:51], v26 offset:16896
    s_waitcnt lgkmcnt(4)
    v_mfma_f32_32x32x16_bf16 v[96:111], v[56:59], v[148:151], v[96:111]
    s_add_u32 m0, s67, 65536
    s_add_u32 s77, s58, 32768
    v_exp_f32 v22, v22
    v_exp_f32 v23, v23
    v_max_f32 v64, 0, v64
    v_max_f32 v65, 0, v65
    v_max_f32 v66, 0, v66
    ds_read_b64_tr_b16 v[52:53], v30 offset:16384
    ds_read_b64_tr_b16 v[54:55], v30 offset:16896
    s_waitcnt lgkmcnt(4)
    v_mfma_f32_32x32x16_bf16 v[112:127], v[60:63], v[148:151], v[112:127]
    buffer_load_dwordx4 v5, s[20:23], s77 offen lds
    v_max_f32 v67, 0, v67
    v_fma_f32 v64, v64, v10, v20
    v_fma_f32 v65, v65, v10, v21
    v_fma_f32 v66, v66, v10, v22
    v_fma_f32 v67, v67, v10, v23
    v_add_f32 v64, 0x358637bd, v64
    v_add_f32 v65, 0x358637bd, v65
    ds_read_b64_tr_b16 v[56:57], v27 offset:16384
    ds_read_b64_tr_b16 v[58:59], v27 offset:16896
    s_waitcnt lgkmcnt(4)
    v_mfma_f32_32x32x16_bf16 v[96:111], v[48:51], v[152:155], v[96:111]
    s_add_u32 s77, s58, 39936
    buffer_load_dwordx4 v5, s[20:23], s77 offen offset:1024 lds
    v_add_f32 v66, 0x358637bd, v66
    v_add_f32 v67, 0x358637bd, v67
    ds_read_b128 v[16:19], v9 offset:32
    s_waitcnt lgkmcnt(0)
    v_mul_f32 v68, v68, v16
    v_mul_f32 v69, v69, v17
    v_mul_f32 v70, v70, v18
    v_mul_f32 v71, v71, v19
    ds_read_b64_tr_b16 v[60:61], v31 offset:16384
    ds_read_b64_tr_b16 v[62:63], v31 offset:16896
    v_mfma_f32_32x32x16_bf16 v[112:127], v[52:55], v[152:155], v[112:127]
    s_waitcnt vmcnt(4)
    s_barrier
    ds_read_b64_tr_b16 v[48:49], v24 offset:32768
    ds_read_b64_tr_b16 v[50:51], v24 offset:33280
    v_mfma_f32_32x32x16_bf16 v[96:111], v[56:59], v[156:159], v[96:111]
    s_add_u32 m0, s63, 0
    s_add_u32 s77, s48, 917504
    v_mul_f32 v84, v84, v16
    v_mul_f32 v85, v85, v17
    v_mul_f32 v86, v86, v18
    v_mul_f32 v87, v87, v19
    v_min_f32 v20, 0, v68
    v_min_f32 v21, 0, v69
    v_min_f32 v22, 0, v70
    ds_read_b64_tr_b16 v[52:53], v28 offset:32768
    ds_read_b64_tr_b16 v[54:55], v28 offset:33280
    s_waitcnt lgkmcnt(4)
    v_mfma_f32_32x32x16_bf16 v[112:127], v[60:63], v[156:159], v[112:127]
    buffer_load_dwordx4 v3, s[12:15], s77 offen lds
    v_min_f32 v23, 0, v71
    v_exp_f32 v20, v20
    v_exp_f32 v21, v21
    v_exp_f32 v22, v22
    ds_read_b64_tr_b16 v[56:57], v25 offset:32768
    ds_read_b64_tr_b16 v[58:59], v25 offset:33280
    s_waitcnt lgkmcnt(4)
    v_mfma_f32_16x16x32_bf16 v[40:43], v[36:39], v[48:51], v[40:43]
    v_mfma_f32_32x32x16_bf16 v[96:111], v[48:51], v[160:163], v[96:111]
    buffer_load_dwordx4 v4, s[16:19], s77 offen offset:1024 lds
    v_exp_f32 v23, v23
    v_max_f32 v68, 0, v68
    v_max_f32 v69, 0, v69
    v_max_f32 v70, 0, v70
    v_max_f32 v71, 0, v71
    v_fma_f32 v68, v68, v10, v20
    ds_read_b64_tr_b16 v[60:61], v29 offset:32768
    ds_read_b64_tr_b16 v[62:63], v29 offset:33280
    s_waitcnt lgkmcnt(4)
    v_mfma_f32_16x16x32_bf16 v[44:47], v[36:39], v[52:55], v[44:47]
    v_mfma_f32_32x32x16_bf16 v[112:127], v[52:55], v[160:163], v[112:127]
    s_cmp_lg_u32 s40, 7
    s_cbranch_scc1 L_pw_B_15
    v_mul_u32_u24 v12, 3584, v1
    s_and_b32 s49, s43, 7
    s_lshl_b32 s49, s49, 3
    s_add_u32 s49, s49, 448
    s_mul_i32 s49, s49, 3584
    s_lshl_b32 s3, s62, 1
    s_add_u32 s49, s49, s3
    s_mov_b64 exec, 0xff
    buffer_load_dword v41, v12, s[12:15], s49 offen
    buffer_load_dword v41, v12, s[16:19], s49 offen offset:1024
    s_mov_b64 exec, -1
L_pw_B_15:
    v_fma_f32 v69, v69, v10, v21
    v_fma_f32 v70, v70, v10, v22
    v_fma_f32 v71, v71, v10, v23
    v_add_f32 v68, 0x358637bd, v68
    v_add_f32 v69, 0x358637bd, v69
    v_add_f32 v70, 0x358637bd, v70
    v_add_f32 v71, 0x358637bd, v71
    ds_read_b64_tr_b16 v[48:49], v26 offset:32768
    ds_read_b64_tr_b16 v[50:51], v26 offset:33280
    s_waitcnt lgkmcnt(4)
    v_mfma_f32_32x32x16_bf16 v[96:111], v[56:59], v[164:167], v[96:111]
    ds_read_b128 v[16:19], v9 offset:64
    s_waitcnt lgkmcnt(0)
    v_mul_f32 v72, v72, v16
    v_mul_f32 v73, v73, v17
    v_mul_f32 v74, v74, v18
    v_mul_f32 v75, v75, v19
    v_mul_f32 v88, v88, v16
    v_mul_f32 v89, v89, v17
    ds_read_b64_tr_b16 v[52:53], v30 offset:32768
    ds_read_b64_tr_b16 v[54:55], v30 offset:33280
    v_mfma_f32_32x32x16_bf16 v[112:127], v[60:63], v[164:167], v[112:127]
    v_mul_f32 v90, v90, v18
    v_mul_f32 v91, v91, v19
    v_min_f32 v20, 0, v72
    v_min_f32 v21, 0, v73
    v_min_f32 v22, 0, v74
    v_min_f32 v23, 0, v75
    v_exp_f32 v20, v20
    ds_read_b64_tr_b16 v[56:57], v27 offset:32768
    ds_read_b64_tr_b16 v[58:59], v27 offset:33280
    v_mfma_f32_32x32x16_bf16 v[96:111], v[48:51], v[168:171], v[96:111]
    v_exp_f32 v21, v21
    v_exp_f32 v22, v22
    v_exp_f32 v23, v23
    v_max_f32 v72, 0, v72
    ds_read_b64_tr_b16 v[60:61], v31 offset:32768
    ds_read_b64_tr_b16 v[62:63], v31 offset:33280
    s_waitcnt lgkmcnt(4)
    v_mfma_f32_32x32x16_bf16 v[112:127], v[52:55], v[168:171], v[112:127]
    s_waitcnt vmcnt(4)
    s_barrier
    ds_read_b64_tr_b16 v[48:49], v24 offset:49152
    ds_read_b64_tr_b16 v[50:51], v24 offset:49664
    s_waitcnt lgkmcnt(4)
    v_mfma_f32_32x32x16_bf16 v[96:111], v[56:59], v[172:175], v[96:111]
    s_add_u32 m0, s63, 16384
    s_add_u32 s77, s48, 1146880
    v_max_f32 v73, 0, v73
    v_max_f32 v74, 0, v74
    v_max_f32 v75, 0, v75
    v_fma_f32 v72, v72, v10, v20
    v_fma_f32 v73, v73, v10, v21
    v_fma_f32 v74, v74, v10, v22
    v_fma_f32 v75, v75, v10, v23
    ds_read_b64_tr_b16 v[52:53], v28 offset:49152
    ds_read_b64_tr_b16 v[54:55], v28 offset:49664
    s_waitcnt lgkmcnt(4)
    v_mfma_f32_32x32x16_bf16 v[112:127], v[60:63], v[172:175], v[112:127]
    buffer_load_dwordx4 v3, s[12:15], s77 offen lds
    v_add_f32 v72, 0x358637bd, v72
    v_add_f32 v73, 0x358637bd, v73
    v_add_f32 v74, 0x358637bd, v74
    v_add_f32 v75, 0x358637bd, v75
    ds_read_b128 v[16:19], v9 offset:96
    s_waitcnt lgkmcnt(0)
    v_mul_f32 v76, v76, v16
    v_mul_f32 v77, v77, v17
    ds_read_b64_tr_b16 v[56:57], v25 offset:49152
    ds_read_b64_tr_b16 v[58:59], v25 offset:49664
    v_mfma_f32_16x16x32_bf16 v[40:43], v[36:39], v[48:51], v[40:43]
    v_mfma_f32_32x32x16_bf16 v[96:111], v[48:51], v[176:179], v[96:111]
    buffer_load_dwordx4 v4, s[16:19], s77 offen offset:1024 lds
    v_mul_f32 v78, v78, v18
    v_mul_f32 v79, v79, v19
    v_mul_f32 v92, v92, v16
    v_mul_f32 v93, v93, v17
    v_mul_f32 v94, v94, v18
    v_mul_f32 v95, v95, v19
    v_min_f32 v20, 0, v76
    ds_read_b64_tr_b16 v[60:61], v29 offset:49152
    ds_read_b64_tr_b16 v[62:63], v29 offset:49664
    v_mfma_f32_16x16x32_bf16 v[44:47], v[36:39], v[52:55], v[44:47]
    v_mfma_f32_32x32x16_bf16 v[112:127], v[52:55], v[176:179], v[112:127]
    s_cmp_lg_u32 s40, 0
    s_cbranch_scc1 L_pw_B_16
    v_mul_u32_u24 v12, 3584, v1
    s_and_b32 s49, s43, 7
    s_lshl_b32 s49, s49, 4
    s_add_u32 s49, s49, 0
    s_mul_i32 s49, s49, 3584
    s_lshl_b32 s3, s73, 1
    s_add_u32 s49, s49, s3
    s_mov_b64 exec, 0xffff
    buffer_load_dword v41, v12, s[12:15], s49 offen
    buffer_load_dword v41, v12, s[16:19], s49 offen offset:1024
    s_mov_b64 exec, -1
L_pw_B_16:
    v_min_f32 v21, 0, v77
    v_min_f32 v22, 0, v78
    v_min_f32 v23, 0, v79
    v_exp_f32 v20, v20
    v_exp_f32 v21, v21
    ds_read_b64_tr_b16 v[48:49], v26 offset:49152
    ds_read_b64_tr_b16 v[50:51], v26 offset:49664
    s_waitcnt lgkmcnt(4)
    v_mfma_f32_32x32x16_bf16 v[96:111], v[56:59], v[180:183], v[96:111]
    s_add_u32 m0, s67, 81920
    s_add_u32 s77, s58, 327680
    v_exp_f32 v22, v22
    v_exp_f32 v23, v23
    v_max_f32 v76, 0, v76
    v_max_f32 v77, 0, v77
    v_max_f32 v78, 0, v78
    ds_read_b64_tr_b16 v[52:53], v30 offset:49152
    ds_read_b64_tr_b16 v[54:55], v30 offset:49664
    s_waitcnt lgkmcnt(4)
    v_mfma_f32_32x32x16_bf16 v[112:127], v[60:63], v[180:183], v[112:127]
    buffer_load_dwordx4 v5, s[20:23], s77 offen lds
    v_max_f32 v79, 0, v79
    v_fma_f32 v76, v76, v10, v20
    v_fma_f32 v77, v77, v10, v21
    v_fma_f32 v78, v78, v10, v22
    v_fma_f32 v79, v79, v10, v23
    v_add_f32 v76, 0x358637bd, v76
    v_add_f32 v77, 0x358637bd, v77
    ds_read_b64_tr_b16 v[56:57], v27 offset:49152
    ds_read_b64_tr_b16 v[58:59], v27 offset:49664
    s_waitcnt lgkmcnt(4)
    v_mfma_f32_32x32x16_bf16 v[96:111], v[48:51], v[184:187], v[96:111]
    s_add_u32 s77, s58, 334848
    buffer_load_dwordx4 v5, s[20:23], s77 offen offset:1024 lds
    v_add_f32 v78, 0x358637bd, v78
    v_add_f32 v79, 0x358637bd, v79
    v_add_f32 v16, v64, v65
    v_add_f32 v17, v66, v67
    v_add_f32 v16, v16, v68
    v_add_f32 v17, v17, v69
    v_add_f32 v16, v16, v70
    ds_read_b64_tr_b16 v[60:61], v31 offset:49152
    ds_read_b64_tr_b16 v[62:63], v31 offset:49664
    s_waitcnt lgkmcnt(4)
    v_mfma_f32_32x32x16_bf16 v[112:127], v[52:55], v[184:187], v[112:127]
    s_waitcnt vmcnt(4)
    s_barrier
    ds_read_b64_tr_b16 v[48:49], v24 offset:0
    ds_read_b64_tr_b16 v[50:51], v24 offset:512
    s_waitcnt lgkmcnt(4)
    v_mfma_f32_32x32x16_bf16 v[96:111], v[56:59], v[188:191], v[96:111]
    s_add_u32 m0, s63, 32768
    s_add_u32 s77, s48, 1376256
    v_add_f32 v17, v17, v71
    v_add_f32 v16, v16, v72
    v_add_f32 v17, v17, v73
    v_add_f32 v16, v16, v74
    v_add_f32 v17, v17, v75
    v_add_f32 v16, v16, v76
    v_add_f32 v17, v17, v77
    ds_read_b64_tr_b16 v[52:53], v28 offset:0
    ds_read_b64_tr_b16 v[54:55], v28 offset:512
    s_waitcnt lgkmcnt(4)
    v_mfma_f32_32x32x16_bf16 v[112:127], v[60:63], v[188:191], v[112:127]
    buffer_load_dwordx4 v3, s[12:15], s77 offen lds
    v_add_f32 v16, v16, v78
    v_add_f32 v17, v17, v79
    v_add_f32 v16, v16, v17
    v_cvt_pk_bf16_f32 v64, v64, v65
    v_cvt_pk_bf16_f32 v65, v66, v67
    v_cvt_pk_bf16_f32 v66, v68, v69
    v_cvt_pk_bf16_f32 v67, v70, v71
    ds_read_b64_tr_b16 v[56:57], v25 offset:0
    ds_read_b64_tr_b16 v[58:59], v25 offset:512
    s_waitcnt lgkmcnt(4)
    v_mfma_f32_16x16x32_bf16 v[40:43], v[36:39], v[48:51], v[40:43]
    v_mfma_f32_32x32x16_bf16 v[96:111], v[48:51], v[192:195], v[96:111]
    buffer_load_dwordx4 v4, s[16:19], s77 offen offset:1024 lds
    v_cvt_pk_bf16_f32 v68, v72, v73
    v_cvt_pk_bf16_f32 v69, v74, v75
    v_cvt_pk_bf16_f32 v70, v76, v77
    v_cvt_pk_bf16_f32 v71, v78, v79
    v_cvt_pk_bf16_f32 v72, v80, v81
    v_cvt_pk_bf16_f32 v73, v82, v83
    v_cvt_pk_bf16_f32 v74, v84, v85
    ds_read_b64_tr_b16 v[60:61], v29 offset:0
    ds_read_b64_tr_b16 v[62:63], v29 offset:512
    s_waitcnt lgkmcnt(4)
    v_mfma_f32_16x16x32_bf16 v[44:47], v[36:39], v[52:55], v[44:47]
    v_mfma_f32_32x32x16_bf16 v[112:127], v[52:55], v[192:195], v[112:127]
    s_cmp_lg_u32 s40, 1
    s_cbranch_scc1 L_pw_B_17
    v_mul_u32_u24 v12, 3584, v1
    s_and_b32 s49, s43, 7
    s_lshl_b32 s49, s49, 4
    s_add_u32 s49, s49, 128
    s_mul_i32 s49, s49, 3584
    s_lshl_b32 s3, s73, 1
    s_add_u32 s49, s49, s3
    s_mov_b64 exec, 0xffff
    buffer_load_dword v41, v12, s[12:15], s49 offen
    buffer_load_dword v41, v12, s[16:19], s49 offen offset:1024
    s_mov_b64 exec, -1
L_pw_B_17:
    v_cvt_pk_bf16_f32 v75, v86, v87
    v_cvt_pk_bf16_f32 v76, v88, v89
    v_cvt_pk_bf16_f32 v77, v90, v91
    v_cvt_pk_bf16_f32 v78, v92, v93
    v_cvt_pk_bf16_f32 v79, v94, v95
    v_mov_b32 v17, v16
    v_mfma_f32_32x32x16_bf16 v[80:95], v[64:67], v[72:75], 0
    ds_read_b64_tr_b16 v[48:49], v26 offset:0
    ds_read_b64_tr_b16 v[50:51], v26 offset:512
    s_waitcnt lgkmcnt(4)
    v_mfma_f32_32x32x16_bf16 v[96:111], v[56:59], v[196:199], v[96:111]
    v_permlane32_swap_b32 v16, v17
    v_mfma_f32_32x32x16_bf16 v[80:95], v[68:71], v[76:79], v[80:95]
    v_add_f32 v16, v16, v17
    v_and_b32 v17, 31, v1
    ds_read_b64_tr_b16 v[52:53], v30 offset:0
    ds_read_b64_tr_b16 v[54:55], v30 offset:512
    s_waitcnt lgkmcnt(4)
    v_mfma_f32_32x32x16_bf16 v[112:127], v[60:63], v[196:199], v[112:127]
    v_lshlrev_b32 v17, 2, v17
    s_lshl_b32 s55, s40, 7
    v_add_u32 v17, s55, v17
    v_add_u32 v17, 154112, v17
    ds_write_b32 v17, v16
    s_nop 0
    v_cndmask_b32 v64, v80, v88, s[56:57]
    v_cndmask_b32 v65, v81, v89, s[56:57]
    v_cndmask_b32 v66, v82, v90, s[56:57]
    ds_read_b64_tr_b16 v[56:57], v27 offset:0
    ds_read_b64_tr_b16 v[58:59], v27 offset:512
    s_waitcnt lgkmcnt(5)
    v_mfma_f32_32x32x16_bf16 v[96:111], v[48:51], v[200:203], v[96:111]
    v_cndmask_b32 v67, v83, v91, s[56:57]
    v_cndmask_b32 v68, v84, v92, s[56:57]
    v_cndmask_b32 v69, v85, v93, s[56:57]
    v_cndmask_b32 v70, v86, v94, s[56:57]
    v_cndmask_b32 v71, v87, v95, s[56:57]
    v_lshlrev_b32 v17, 5, v1
    v_add_u32 v17, s63, v17
    ds_read_b64_tr_b16 v[60:61], v31 offset:0
    ds_read_b64_tr_b16 v[62:63], v31 offset:512
    s_waitcnt lgkmcnt(5)
    v_mfma_f32_32x32x16_bf16 v[112:127], v[52:55], v[200:203], v[112:127]
    v_add_u32 v17, 114688, v17
    ds_write_b128 v17, v[64:67]
    ds_write_b128 v17, v[68:71] offset:16
    s_waitcnt vmcnt(4)
    s_waitcnt lgkmcnt(0)
    s_barrier
    ds_read_b64_tr_b16 v[48:49], v24 offset:16384
    ds_read_b64_tr_b16 v[50:51], v24 offset:16896
    v_mfma_f32_32x32x16_bf16 v[96:111], v[56:59], v[204:207], v[96:111]
    s_add_u32 m0, s63, 49152
    s_add_u32 s77, s48, 1605632
    v_lshlrev_b32 v9, 5, v1
    s_lshl_b32 s55, s42, 13
    s_lshl_b32 s54, s41, 3
    s_add_u32 s55, s55, s54
    s_add_u32 s55, s55, 114688
    v_add_u32 v9, s55, v9
    ds_read_b64 v[16:17], v9
    ds_read_b64 v[18:19], v9 offset:2048
    ds_read_b64 v[20:21], v9 offset:4096
    ds_read_b64_tr_b16 v[52:53], v28 offset:16384
    ds_read_b64_tr_b16 v[54:55], v28 offset:16896
    v_mfma_f32_32x32x16_bf16 v[112:127], v[60:63], v[204:207], v[112:127]
    buffer_load_dwordx4 v3, s[12:15], s77 offen lds
    ds_read_b64 v[22:23], v9 offset:6144
    v_and_b32 v10, 15, v1
    v_lshlrev_b32 v10, 6, v10
    v_lshrrev_b32 v11, 4, v1
    v_and_b32 v11, 1, v11
    v_mul_u32_u24 v0, 1152, v11
    v_add_u32 v10, v10, v0
    ds_read_b64_tr_b16 v[56:57], v25 offset:16384
    ds_read_b64_tr_b16 v[58:59], v25 offset:16896
    s_waitcnt lgkmcnt(8)
    v_mfma_f32_16x16x32_bf16 v[40:43], v[36:39], v[48:51], v[40:43]
    v_mfma_f32_32x32x16_bf16 v[96:111], v[48:51], v[208:211], v[96:111]
    buffer_load_dwordx4 v4, s[16:19], s77 offen offset:1024 lds
    v_lshrrev_b32 v11, 5, v1
    v_lshlrev_b32 v11, 5, v11
    v_add_u32 v10, v10, v11
    s_lshl_b32 s54, s41, 3
    v_add_u32 v10, s54, v10
    s_waitcnt lgkmcnt(6)
    v_add_f32 v16, v16, v18
    v_add_f32 v17, v17, v19
    s_waitcnt lgkmcnt(2)
    v_add_f32 v20, v20, v22
    ds_read_b64_tr_b16 v[60:61], v29 offset:16384
    ds_read_b64_tr_b16 v[62:63], v29 offset:16896
    v_mfma_f32_16x16x32_bf16 v[44:47], v[36:39], v[52:55], v[44:47]
    v_mfma_f32_32x32x16_bf16 v[112:127], v[52:55], v[208:211], v[112:127]
    s_cmp_lg_u32 s40, 2
    s_cbranch_scc1 L_pw_B_18
    v_mul_u32_u24 v12, 3584, v1
    s_and_b32 s49, s43, 7
    s_lshl_b32 s49, s49, 4
    s_add_u32 s49, s49, 256
    s_mul_i32 s49, s49, 3584
    s_lshl_b32 s3, s73, 1
    s_add_u32 s49, s49, s3
    s_mov_b64 exec, 0xffff
    buffer_load_dword v41, v12, s[12:15], s49 offen
    buffer_load_dword v41, v12, s[16:19], s49 offen offset:1024
    s_mov_b64 exec, -1
L_pw_B_18:
    v_add_f32 v21, v21, v23
    v_add_f32 v16, v16, v20
    v_add_f32 v17, v17, v21
    v_mul_f32 v16, 0x3f317218, v16
    v_mul_f32 v17, 0x3f317218, v17
    buffer_store_dwordx2 v[16:17], v10, s[32:35], s66 offen sc1
    v_and_b32 v9, 31, v1
    ds_read_b64_tr_b16 v[48:49], v26 offset:16384
    ds_read_b64_tr_b16 v[50:51], v26 offset:16896
    s_waitcnt lgkmcnt(4)
    v_mfma_f32_32x32x16_bf16 v[96:111], v[56:59], v[212:215], v[96:111]
    s_add_u32 m0, s67, 98304
    s_add_u32 s77, s58, 360448
    v_lshlrev_b32 v11, 2, v9
    s_lshl_b32 s55, s42, 9
    s_add_u32 s55, s55, 154112
    v_add_u32 v11, s55, v11
    ds_read_b32 v18, v11
    ds_read_b32 v19, v11 offset:128
    ds_read_b32 v20, v11 offset:256
    ds_read_b32 v21, v11 offset:384
    ds_read_b64_tr_b16 v[52:53], v30 offset:16384
    ds_read_b64_tr_b16 v[54:55], v30 offset:16896
    s_waitcnt lgkmcnt(8)
    v_mfma_f32_32x32x16_bf16 v[112:127], v[60:63], v[212:215], v[112:127]
    buffer_load_dwordx4 v5, s[20:23], s77 offen lds
    v_lshrrev_b32 v10, 4, v9
    v_mul_u32_u24 v10, 1152, v10
    v_and_b32 v11, 3, v9
    v_lshrrev_b32 v0, 3, v9
    v_and_b32 v0, 1, v0
    v_lshlrev_b32 v0, 2, v0
    v_add_u32 v11, v11, v0
    ds_read_b64_tr_b16 v[56:57], v27 offset:16384
    ds_read_b64_tr_b16 v[58:59], v27 offset:16896
    s_waitcnt lgkmcnt(8)
    v_mfma_f32_32x32x16_bf16 v[96:111], v[48:51], v[216:219], v[96:111]
    s_add_u32 s77, s58, 367616
    buffer_load_dwordx4 v5, s[20:23], s77 offen offset:1024 lds
    v_lshrrev_b32 v0, 2, v9
    v_and_b32 v0, 1, v0
    v_lshlrev_b32 v0, 3, v0
    v_add_u32 v11, v11, v0
    v_lshlrev_b32 v11, 2, v11
    v_add_u32 v10, v10, v11
    v_add_u32 v10, 1024, v10
    ds_read_b64_tr_b16 v[60:61], v31 offset:16384
    ds_read_b64_tr_b16 v[62:63], v31 offset:16896
    s_waitcnt lgkmcnt(4)
    v_mfma_f32_32x32x16_bf16 v[112:127], v[52:55], v[216:219], v[112:127]
    s_waitcnt vmcnt(5)
    s_barrier
    ds_read_b64_tr_b16 v[48:49], v24 offset:32768
    ds_read_b64_tr_b16 v[50:51], v24 offset:33280
    s_waitcnt lgkmcnt(4)
    v_mfma_f32_32x32x16_bf16 v[96:111], v[56:59], v[220:223], v[96:111]
    v_lshrrev_b32 v3, 2, v1
    s_cmp_eq_u32 s41, 0
    s_cselect_b32 s55, 32, 0
    v_mov_b32 v11, 2130706432
    v_cmp_gt_u32 vcc, s55, v1
    v_add_f32 v18, v18, v19
    v_add_f32 v20, v20, v21
    v_cndmask_b32 v10, v11, v10, vcc
    v_add_f32 v18, v18, v20
    ds_read_b64_tr_b16 v[52:53], v28 offset:32768
    ds_read_b64_tr_b16 v[54:55], v28 offset:33280
    s_waitcnt lgkmcnt(4)
    v_mfma_f32_32x32x16_bf16 v[112:127], v[60:63], v[220:223], v[112:127]
    v_and_b32 v4, 3, v1
    buffer_store_dword v18, v10, s[32:35], s66 offen sc1
    v_lshrrev_b32 v9, 2, v1
    v_and_b32 v9, 3, v9
    v_and_b32 v13, 3, v1
    v_lshlrev_b32 v13, 3, v13
    v_lshrrev_b32 v10, 4, v1
    v_and_b32 v10, 1, v10
    ds_read_b64_tr_b16 v[56:57], v25 offset:32768
    ds_read_b64_tr_b16 v[58:59], v25 offset:33280
    s_waitcnt lgkmcnt(4)
    v_mfma_f32_16x16x32_bf16 v[40:43], v[36:39], v[48:51], v[40:43]
    v_mfma_f32_32x32x16_bf16 v[96:111], v[48:51], v[224:227], v[96:111]
    v_lshlrev_b32 v4, 4, v4
    v_lshrrev_b32 v11, 5, v1
    v_lshlrev_b32 v11, 9, v11
    v_add_u32 v13, v13, v11
    v_lshlrev_b32 v11, 10, v10
    v_add_u32 v13, v13, v11
    v_lshlrev_b32 v11, 6, v9
    v_add_u32 v13, v13, v11
    ds_read_b64_tr_b16 v[60:61], v29 offset:32768
    ds_read_b64_tr_b16 v[62:63], v29 offset:33280
    s_waitcnt lgkmcnt(4)
    v_mfma_f32_16x16x32_bf16 v[44:47], v[36:39], v[52:55], v[44:47]
    v_mfma_f32_32x32x16_bf16 v[112:127], v[52:55], v[224:227], v[112:127]
    v_mul_u32_u24 v3, 3584, v3
    v_xor_b32 v10, s42, v10
    v_lshlrev_b32 v10, 5, v10
    v_add_u32 v13, v13, v10
    s_lshl_b32 s55, s46, 11
    v_add_u32 v13, s55, v13
    ds_read_b64_tr_b16 v[48:49], v26 offset:32768
    ds_read_b64_tr_b16 v[50:51], v26 offset:33280
    s_waitcnt lgkmcnt(4)
    v_mfma_f32_32x32x16_bf16 v[96:111], v[56:59], v[228:231], v[96:111]
    v_add_u32 v3, v3, v4
    ds_read_b64_tr_b16 v[52:53], v30 offset:32768
    ds_read_b64_tr_b16 v[54:55], v30 offset:33280
    s_waitcnt lgkmcnt(4)
    v_mfma_f32_32x32x16_bf16 v[112:127], v[60:63], v[228:231], v[112:127]
    v_xor_b32 v4, 32, v3
    ds_read_b64_tr_b16 v[56:57], v27 offset:32768
    ds_read_b64_tr_b16 v[58:59], v27 offset:33280
    s_waitcnt lgkmcnt(4)
    v_mfma_f32_32x32x16_bf16 v[96:111], v[48:51], v[232:235], v[96:111]
    s_mul_i32 s48, s40, 57344
    s_lshl_b32 s77, s73, 1
    ds_read_b64_tr_b16 v[60:61], v31 offset:32768
    ds_read_b64_tr_b16 v[62:63], v31 offset:33280
    s_waitcnt lgkmcnt(4)
    v_mfma_f32_32x32x16_bf16 v[112:127], v[52:55], v[232:235], v[112:127]
    s_add_u32 s48, s48, s77
    s_add_u32 m0, s63, 0
    s_add_u32 s77, s48, 0
    buffer_load_dwordx4 v3, s[12:15], s77 offen lds
    buffer_load_dwordx4 v4, s[16:19], s77 offen offset:1024 lds
    s_cmp_lg_u32 s40, 3
    s_cbranch_scc1 L_pw_B_19
    v_mul_u32_u24 v12, 3584, v1
    s_and_b32 s49, s43, 7
    s_lshl_b32 s49, s49, 4
    s_add_u32 s49, s49, 384
    s_mul_i32 s49, s49, 3584
    s_lshl_b32 s3, s73, 1
    s_add_u32 s49, s49, s3
    s_mov_b64 exec, 0xffff
    buffer_load_dword v41, v12, s[12:15], s49 offen
    buffer_load_dword v41, v12, s[16:19], s49 offen offset:1024
    s_mov_b64 exec, -1
L_pw_B_19:
    s_waitcnt vmcnt(6)
    s_waitcnt lgkmcnt(0)
    s_barrier
    ds_read_b64_tr_b16 v[48:49], v24 offset:49152
    ds_read_b64_tr_b16 v[50:51], v24 offset:49664
    v_xor_b32 v24, 0, v13
    v_mfma_f32_32x32x16_bf16 v[96:111], v[56:59], v[236:239], v[96:111]
    s_add_u32 m0, s63, 16384
    s_add_u32 s77, s48, 458752
    ds_read_b64_tr_b16 v[52:53], v28 offset:49152
    ds_read_b64_tr_b16 v[54:55], v28 offset:49664
    v_mfma_f32_32x32x16_bf16 v[112:127], v[60:63], v[236:239], v[112:127]
    buffer_load_dwordx4 v3, s[12:15], s77 offen lds
    ds_read_b64_tr_b16 v[56:57], v25 offset:49152
    ds_read_b64_tr_b16 v[58:59], v25 offset:49664
    v_xor_b32 v25, 2048, v13
    s_waitcnt lgkmcnt(4)
    v_mfma_f32_16x16x32_bf16 v[40:43], v[36:39], v[48:51], v[40:43]
    v_mfma_f32_32x32x16_bf16 v[96:111], v[48:51], v[240:243], v[96:111]
    buffer_load_dwordx4 v4, s[16:19], s77 offen offset:1024 lds
    ds_read_b64_tr_b16 v[60:61], v29 offset:49152
    ds_read_b64_tr_b16 v[62:63], v29 offset:49664
    s_waitcnt lgkmcnt(4)
    v_mfma_f32_16x16x32_bf16 v[44:47], v[36:39], v[52:55], v[44:47]
    v_mfma_f32_32x32x16_bf16 v[112:127], v[52:55], v[240:243], v[112:127]
    s_nop 0
    ds_write_b32 v15, v40 offset:0
    s_nop 4
    ds_write_b32 v15, v44 offset:512
    ds_read_b64_tr_b16 v[48:49], v26 offset:49152
    ds_read_b64_tr_b16 v[50:51], v26 offset:49664
    v_xor_b32 v26, 4096, v13
    s_waitcnt lgkmcnt(6)
    v_mfma_f32_32x32x16_bf16 v[96:111], v[56:59], v[244:247], v[96:111]
    ds_read_b64_tr_b16 v[52:53], v30 offset:49152
    ds_read_b64_tr_b16 v[54:55], v30 offset:49664
    s_waitcnt lgkmcnt(6)
    v_mfma_f32_32x32x16_bf16 v[112:127], v[60:63], v[244:247], v[112:127]
    ds_read_b64_tr_b16 v[56:57], v27 offset:49152
    ds_read_b64_tr_b16 v[58:59], v27 offset:49664
    v_xor_b32 v27, 6144, v13
    s_waitcnt lgkmcnt(4)
    v_mfma_f32_32x32x16_bf16 v[96:111], v[48:51], v[248:251], v[96:111]
    ds_read_b64_tr_b16 v[60:61], v31 offset:49152
    ds_read_b64_tr_b16 v[62:63], v31 offset:49664
    s_waitcnt lgkmcnt(4)
    v_mfma_f32_32x32x16_bf16 v[112:127], v[52:55], v[248:251], v[112:127]
    s_waitcnt vmcnt(4)
    s_waitcnt vmcnt(2)
    s_waitcnt lgkmcnt(0)
    s_barrier
    ds_read_b64_tr_b16 v[48:49], v24 offset:0
    ds_read_b64_tr_b16 v[50:51], v24 offset:256
    v_mfma_f32_32x32x16_bf16 v[96:111], v[56:59], v[252:255], v[96:111]
    s_add_u32 m0, s63, 32768
    s_add_u32 s77, s48, 917504
    s_cmp_lg_u32 s40, 0
    s_cbranch_scc1 L_fl_f2B
    s_lshl_b32 s54, s45, 7
    s_lshl_b32 s55, s43, 2
    s_add_u32 s54, s54, s55
    s_add_u32 s54, s54, 12587008
    v_mov_b32 v9, s51
    v_mov_b32 v10, 0
    s_mov_b64 s[68:69], exec
    s_mov_b64 exec, 1
    buffer_store_dword v9, v10, s[32:35], s54 offen sc1
    s_mov_b64 exec, s[68:69]
L_fl_f2B:
    ds_read_b64_tr_b16 v[52:53], v25 offset:0
    ds_read_b64_tr_b16 v[54:55], v25 offset:256
    s_nop 1
    v_mfma_f32_32x32x16_bf16 v[112:127], v[60:63], v[252:255], v[112:127]
    buffer_load_dwordx4 v3, s[12:15], s77 offen lds
    ds_read_b128 v[16:19], v14 offset:0
    s_waitcnt lgkmcnt(0)
    v_add_f32 v16, v16, v17
    v_add_f32 v18, v18, v19
    v_mov_b32 v22, 0
    v_add_f32 v16, v16, v18
    v_mov_b32 v23, 0
    v_cvt_pk_bf16_f32 v20, v16, v16
    ds_read_b64_tr_b16 v[56:57], v26 offset:0
    ds_read_b64_tr_b16 v[58:59], v26 offset:256
    v_mfma_f32_16x16x32_bf16 v[40:43], v[36:39], v[48:51], 0
    v_mfma_f32_32x32x16_bf16 v[64:79], v[48:51], v[128:131], 0
    buffer_load_dwordx4 v4, s[16:19], s77 offen offset:1024 lds
    v_and_b32 v17, 0xffff0000, v20
    v_sub_f32 v16, v16, v17
    v_cvt_pk_bf16_f32 v21, v16, 0
    s_nop 1
    v_mfma_f32_32x32x16_bf16 v[96:111], v[20:23], v[32:35], v[96:111]
    ds_read_b64_tr_b16 v[60:61], v27 offset:0
    ds_read_b64_tr_b16 v[62:63], v27 offset:256
    v_mfma_f32_32x32x16_bf16 v[64:79], v[52:55], v[132:135], v[64:79]
    ds_read_b128 v[16:19], v14 offset:512
    s_waitcnt lgkmcnt(0)
    v_add_f32 v16, v16, v17
    v_add_f32 v18, v18, v19
    v_mov_b32 v22, 0
    v_add_f32 v16, v16, v18
    v_mov_b32 v23, 0
    ds_read_b64_tr_b16 v[48:49], v24 offset:8192
    ds_read_b64_tr_b16 v[50:51], v24 offset:8448
    v_mfma_f32_32x32x16_bf16 v[64:79], v[56:59], v[136:139], v[64:79]
    v_cvt_pk_bf16_f32 v20, v16, v16
    v_and_b32 v17, 0xffff0000, v20
    v_sub_f32 v16, v16, v17
    v_cvt_pk_bf16_f32 v21, v16, 0
    s_nop 1
    v_mfma_f32_32x32x16_bf16 v[112:127], v[20:23], v[32:35], v[112:127]
    ds_read_b64_tr_b16 v[52:53], v25 offset:8192
    ds_read_b64_tr_b16 v[54:55], v25 offset:8448
    v_mfma_f32_32x32x16_bf16 v[64:79], v[60:63], v[140:143], v[64:79]
    v_mul_f32 v96, v6, v96
    v_mul_f32 v97, v6, v97
    v_mul_f32 v98, v6, v98
    v_mul_f32 v99, v6, v99
    v_exp_f32 v16, v96
    ds_read_b64_tr_b16 v[56:57], v26 offset:8192
    ds_read_b64_tr_b16 v[58:59], v26 offset:8448
    s_waitcnt lgkmcnt(4)
    v_mfma_f32_16x16x32_bf16 v[40:43], v[36:39], v[48:51], v[40:43]
    v_mfma_f32_32x32x16_bf16 v[64:79], v[48:51], v[144:147], v[64:79]
    v_exp_f32 v17, v97
    v_exp_f32 v18, v98
    v_exp_f32 v19, v99
    ds_read_b64_tr_b16 v[60:61], v27 offset:8192
    ds_read_b64_tr_b16 v[62:63], v27 offset:8448
    s_waitcnt lgkmcnt(4)
    v_mfma_f32_32x32x16_bf16 v[64:79], v[52:55], v[148:151], v[64:79]
    s_waitcnt vmcnt(2)
    s_barrier
    ds_read_b64_tr_b16 v[48:49], v24 offset:16384
    ds_read_b64_tr_b16 v[50:51], v24 offset:16640
    s_waitcnt lgkmcnt(4)
    v_mfma_f32_32x32x16_bf16 v[64:79], v[56:59], v[152:155], v[64:79]
    s_add_u32 m0, s63, 49152
    s_add_u32 s77, s48, 1376256
    v_mul_f32 v104, v104, v96
    v_mul_f32 v105, v105, v97
    v_mul_f32 v106, v106, v98
    v_mul_f32 v107, v107, v99
    v_fma_f32 v16, v16, v7, v7
    v_fma_f32 v17, v17, v7, v7
    ds_read_b64_tr_b16 v[52:53], v25 offset:16384
    ds_read_b64_tr_b16 v[54:55], v25 offset:16640
    s_waitcnt lgkmcnt(4)
    v_mfma_f32_32x32x16_bf16 v[64:79], v[60:63], v[156:159], v[64:79]
    buffer_load_dwordx4 v3, s[12:15], s77 offen lds
    v_fma_f32 v18, v18, v7, v7
    v_fma_f32 v19, v19, v7, v7
    v_rcp_f32 v16, v16
    v_rcp_f32 v17, v17
    ds_read_b64_tr_b16 v[56:57], v26 offset:16384
    ds_read_b64_tr_b16 v[58:59], v26 offset:16640
    s_waitcnt lgkmcnt(4)
    v_mfma_f32_16x16x32_bf16 v[40:43], v[36:39], v[48:51], v[40:43]
    v_mfma_f32_32x32x16_bf16 v[64:79], v[48:51], v[160:163], v[64:79]
    buffer_load_dwordx4 v4, s[16:19], s77 offen offset:1024 lds
    v_rcp_f32 v18, v18
    v_rcp_f32 v19, v19
    v_mul_f32 v96, v104, v16
    v_mul_f32 v97, v105, v17
    ds_read_b64_tr_b16 v[60:61], v27 offset:16384
    ds_read_b64_tr_b16 v[62:63], v27 offset:16640
    s_waitcnt lgkmcnt(4)
    v_mfma_f32_32x32x16_bf16 v[64:79], v[52:55], v[164:167], v[64:79]
    s_add_u32 m0, s67, 114688
    s_add_u32 s77, s58, 65536
    v_mul_f32 v98, v106, v18
    v_mul_f32 v99, v107, v19
    v_mul_f32 v100, v6, v100
    v_mul_f32 v101, v6, v101
    v_mul_f32 v102, v6, v102
    v_mul_f32 v103, v6, v103
    ds_read_b64_tr_b16 v[48:49], v24 offset:24576
    ds_read_b64_tr_b16 v[50:51], v24 offset:24832
    s_waitcnt lgkmcnt(4)
    v_mfma_f32_32x32x16_bf16 v[64:79], v[56:59], v[168:171], v[64:79]
    buffer_load_dwordx4 v5, s[20:23], s77 offen lds
    v_exp_f32 v16, v100
    v_exp_f32 v17, v101
    v_exp_f32 v18, v102
    ds_read_b64_tr_b16 v[52:53], v25 offset:24576
    ds_read_b64_tr_b16 v[54:55], v25 offset:24832
    s_waitcnt lgkmcnt(4)
    v_mfma_f32_32x32x16_bf16 v[64:79], v[60:63], v[172:175], v[64:79]
    s_add_u32 s77, s58, 72704
    buffer_load_dwordx4 v5, s[20:23], s77 offen offset:1024 lds
    v_exp_f32 v19, v103
    v_mul_f32 v108, v108, v100
    v_mul_f32 v109, v109, v101
    v_mul_f32 v110, v110, v102
    v_mul_f32 v111, v111, v103
    ds_read_b64_tr_b16 v[56:57], v26 offset:24576
    ds_read_b64_tr_b16 v[58:59], v26 offset:24832
    s_waitcnt lgkmcnt(4)
    v_mfma_f32_16x16x32_bf16 v[40:43], v[36:39], v[48:51], v[40:43]
    v_mfma_f32_32x32x16_bf16 v[64:79], v[48:51], v[176:179], v[64:79]
    v_fma_f32 v16, v16, v7, v7
    v_fma_f32 v17, v17, v7, v7
    v_fma_f32 v18, v18, v7, v7
    v_fma_f32 v19, v19, v7, v7
    v_rcp_f32 v16, v16
    ds_read_b64_tr_b16 v[60:61], v27 offset:24576
    ds_read_b64_tr_b16 v[62:63], v27 offset:24832
    s_waitcnt lgkmcnt(4)
    v_mfma_f32_32x32x16_bf16 v[64:79], v[52:55], v[180:183], v[64:79]
    s_waitcnt vmcnt(4)
    s_barrier
    ds_read_b64_tr_b16 v[48:49], v24 offset:32768
    ds_read_b64_tr_b16 v[50:51], v24 offset:33024
    s_waitcnt lgkmcnt(4)
    v_mfma_f32_32x32x16_bf16 v[64:79], v[56:59], v[184:187], v[64:79]
    v_rcp_f32 v17, v17
    v_rcp_f32 v18, v18
    v_rcp_f32 v19, v19
    ds_read_b64_tr_b16 v[52:53], v25 offset:32768
    ds_read_b64_tr_b16 v[54:55], v25 offset:33024
    s_waitcnt lgkmcnt(4)
    v_mfma_f32_32x32x16_bf16 v[64:79], v[60:63], v[188:191], v[64:79]
    v_mul_f32 v100, v108, v16
    v_mul_f32 v101, v109, v17
    v_mul_f32 v102, v110, v18
    v_mul_f32 v103, v111, v19
    v_cvt_pk_bf16_f32 v96, v96, v97
    v_cvt_pk_bf16_f32 v97, v98, v99
    ds_read_b64_tr_b16 v[56:57], v26 offset:32768
    ds_read_b64_tr_b16 v[58:59], v26 offset:33024
    s_waitcnt lgkmcnt(4)
    v_mfma_f32_16x16x32_bf16 v[40:43], v[36:39], v[48:51], v[40:43]
    v_mfma_f32_32x32x16_bf16 v[64:79], v[48:51], v[192:195], v[64:79]
    v_cvt_pk_bf16_f32 v98, v100, v101
    v_cvt_pk_bf16_f32 v99, v102, v103
    s_lshr_b32 s54, s62, 4
    s_mul_i32 s55, s42, 2
    s_add_u32 s54, s54, s55
    s_add_u32 s54, s54, 0
    s_lshl_b32 s54, s54, 10
    s_add_u32 s54, s54, s50
    buffer_store_dwordx4 v[96:99], v2, s[32:35], s54 offen sc1
    ds_read_b64_tr_b16 v[60:61], v27 offset:32768
    ds_read_b64_tr_b16 v[62:63], v27 offset:33024
    s_waitcnt lgkmcnt(4)
    v_mfma_f32_32x32x16_bf16 v[64:79], v[52:55], v[196:199], v[64:79]
    v_mul_f32 v112, v6, v112
    v_mul_f32 v113, v6, v113
    v_mul_f32 v114, v6, v114
    v_mul_f32 v115, v6, v115
    v_exp_f32 v16, v112
    ds_read_b64_tr_b16 v[48:49], v24 offset:40960
    ds_read_b64_tr_b16 v[50:51], v24 offset:41216
    s_waitcnt lgkmcnt(4)
    v_mfma_f32_32x32x16_bf16 v[64:79], v[56:59], v[200:203], v[64:79]
    v_exp_f32 v17, v113
    v_exp_f32 v18, v114
    v_exp_f32 v19, v115
    ds_read_b64_tr_b16 v[52:53], v25 offset:40960
    ds_read_b64_tr_b16 v[54:55], v25 offset:41216
    s_waitcnt lgkmcnt(4)
    v_mfma_f32_32x32x16_bf16 v[64:79], v[60:63], v[204:207], v[64:79]
    v_mul_f32 v120, v120, v112
    v_mul_f32 v121, v121, v113
    v_mul_f32 v122, v122, v114
    v_mul_f32 v123, v123, v115
    v_fma_f32 v16, v16, v7, v7
    v_fma_f32 v17, v17, v7, v7
    ds_read_b64_tr_b16 v[56:57], v26 offset:40960
    ds_read_b64_tr_b16 v[58:59], v26 offset:41216
    s_waitcnt lgkmcnt(4)
    v_mfma_f32_16x16x32_bf16 v[40:43], v[36:39], v[48:51], v[40:43]
    v_mfma_f32_32x32x16_bf16 v[64:79], v[48:51], v[208:211], v[64:79]
    v_fma_f32 v18, v18, v7, v7
    v_fma_f32 v19, v19, v7, v7
    v_rcp_f32 v16, v16
    v_rcp_f32 v17, v17
    ds_read_b64_tr_b16 v[60:61], v27 offset:40960
    ds_read_b64_tr_b16 v[62:63], v27 offset:41216
    s_waitcnt lgkmcnt(4)
    v_mfma_f32_32x32x16_bf16 v[64:79], v[52:55], v[212:215], v[64:79]
    v_rcp_f32 v18, v18
    v_rcp_f32 v19, v19
    v_mul_f32 v112, v120, v16
    v_mul_f32 v113, v121, v17
    v_mul_f32 v114, v122, v18
    v_mul_f32 v115, v123, v19
    v_mul_f32 v116, v6, v116
    v_mul_f32 v117, v6, v117
    v_mul_f32 v118, v6, v118
    v_mul_f32 v119, v6, v119
    v_exp_f32 v16, v116
    v_exp_f32 v17, v117
    v_exp_f32 v18, v118
    v_exp_f32 v19, v119
    v_mul_f32 v124, v124, v116
    v_mul_f32 v125, v125, v117
    v_mul_f32 v126, v126, v118
    v_mul_f32 v127, v127, v119
    v_fma_f32 v16, v16, v7, v7
    v_fma_f32 v17, v17, v7, v7
    v_fma_f32 v18, v18, v7, v7
    v_fma_f32 v19, v19, v7, v7
    v_rcp_f32 v16, v16
    v_rcp_f32 v17, v17
    v_rcp_f32 v18, v18
    v_rcp_f32 v19, v19
    v_mul_f32 v116, v124, v16
    v_mul_f32 v117, v125, v17
    v_mul_f32 v118, v126, v18
    v_mul_f32 v119, v127, v19
    v_cvt_pk_bf16_f32 v112, v112, v113
    v_cvt_pk_bf16_f32 v113, v114, v115
    v_cvt_pk_bf16_f32 v114, v116, v117
    v_cvt_pk_bf16_f32 v115, v118, v119
    s_lshr_b32 s54, s62, 4
    s_mul_i32 s55, s42, 2
    s_add_u32 s54, s54, s55
    s_add_u32 s54, s54, 1
    s_lshl_b32 s54, s54, 10
    s_add_u32 s54, s54, s50
    buffer_store_dwordx4 v[112:115], v2, s[32:35], s54 offen sc1
    s_cmp_lg_u32 s40, 3
    s_cbranch_scc1 L_r1_B
    v_and_b32 v9, 15, v1
    v_lshlrev_b32 v9, 2, v9
    s_lshr_b32 s54, s70, 2
    s_lshl_b32 s54, s54, 7
    s_add_u32 s54, s54, 12587008
    buffer_load_dword v80, v9, s[32:35], s54 offen sc1
L_r1_B:
    s_waitcnt vmcnt(4)
    s_barrier
    ds_read_b64_tr_b16 v[48:49], v24 offset:49152
    ds_read_b64_tr_b16 v[50:51], v24 offset:49408
    s_waitcnt lgkmcnt(4)
    v_mfma_f32_32x32x16_bf16 v[64:79], v[56:59], v[216:219], v[64:79]
    v_and_b32 v9, 7, v1
    v_lshlrev_b32 v9, 3, v9
    s_lshr_b32 s54, s64, 1
    s_lshl_b32 s54, s54, 7
    s_add_u32 s54, s54, 12582912
    buffer_load_dword v95, v9, s[32:35], s54 offen sc1
    ds_read_b64_tr_b16 v[52:53], v25 offset:49152
    ds_read_b64_tr_b16 v[54:55], v25 offset:49408
    s_waitcnt lgkmcnt(4)
    v_mfma_f32_32x32x16_bf16 v[64:79], v[60:63], v[220:223], v[64:79]
    ds_read_b64_tr_b16 v[56:57], v26 offset:49152
    ds_read_b64_tr_b16 v[58:59], v26 offset:49408
    s_waitcnt lgkmcnt(4)
    v_mfma_f32_16x16x32_bf16 v[40:43], v[36:39], v[48:51], v[40:43]
    v_mfma_f32_32x32x16_bf16 v[64:79], v[48:51], v[224:227], v[64:79]
    ds_read_b64_tr_b16 v[60:61], v27 offset:49152
    ds_read_b64_tr_b16 v[62:63], v27 offset:49408
    s_waitcnt lgkmcnt(4)
    v_mfma_f32_32x32x16_bf16 v[64:79], v[52:55], v[228:231], v[64:79]
    ds_read_b64_tr_b16 v[48:49], v24 offset:57344
    ds_read_b64_tr_b16 v[50:51], v24 offset:57600
    s_waitcnt lgkmcnt(4)
    v_mfma_f32_32x32x16_bf16 v[64:79], v[56:59], v[232:235], v[64:79]
    ds_read_b64_tr_b16 v[52:53], v25 offset:57344
    ds_read_b64_tr_b16 v[54:55], v25 offset:57600
    s_waitcnt lgkmcnt(4)
    v_mfma_f32_32x32x16_bf16 v[64:79], v[60:63], v[236:239], v[64:79]
    ds_read_b64_tr_b16 v[56:57], v26 offset:57344
    ds_read_b64_tr_b16 v[58:59], v26 offset:57600
    s_waitcnt lgkmcnt(4)
    v_mfma_f32_16x16x32_bf16 v[40:43], v[36:39], v[48:51], v[40:43]
    v_mfma_f32_32x32x16_bf16 v[64:79], v[48:51], v[240:243], v[64:79]
    s_nop 6
    ds_write_b32 v15, v40 offset:0
    ds_read_b64_tr_b16 v[60:61], v27 offset:57344
    ds_read_b64_tr_b16 v[62:63], v27 offset:57600
    s_waitcnt lgkmcnt(5)
    v_mfma_f32_32x32x16_bf16 v[64:79], v[52:55], v[244:247], v[64:79]
    s_waitcnt lgkmcnt(3)
    v_mfma_f32_32x32x16_bf16 v[64:79], v[56:59], v[248:251], v[64:79]
    s_waitcnt lgkmcnt(0)
    v_mfma_f32_32x32x16_bf16 v[64:79], v[60:63], v[252:255], v[64:79]
    s_waitcnt vmcnt(3)
    s_waitcnt lgkmcnt(0)
    s_barrier
    s_lshl_b32 s52, s64, 1
    s_add_u32 s52, s52, s79
    s_mul_i32 s52, s52, 147456
    s_add_u32 s52, s52, 0
    s_mul_i32 s60, s78, 28672
    s_add_u32 s60, s60, s52
    s_lshl_b32 s61, s78, 13
    s_add_u32 s61, s61, s52
    s_add_u32 s61, s61, 114688
    s_waitcnt vmcnt(0)
    v_cmp_eq_u32 vcc, s51, v95
    s_mov_b32 s72, 0
    s_nop 1
    s_cmp_eq_u64 vcc, exec
    s_cbranch_scc1 L_f1aok_B
    v_and_b32 v9, 7, v1
    v_lshlrev_b32 v9, 3, v9
    s_lshr_b32 s54, s64, 1
    s_lshl_b32 s54, s54, 7
    s_add_u32 s54, s54, 12582912
L_f1al_B:
    buffer_load_dword v95, v9, s[32:35], s54 offen sc1
    s_waitcnt vmcnt(0)
    v_cmp_eq_u32 vcc, s51, v95
    s_add_u32 s72, s72, 1
    s_cmp_gt_u32 s72, 0x80000
    s_cbranch_scc1 L_f1aok_B
    s_cmp_eq_u64 vcc, exec
    s_cbranch_scc1 L_f1aok_B
    s_sleep 4
    s_branch L_f1al_B
L_f1aok_B:
    buffer_load_dwordx4 v[208:211], v2, s[32:35], s60 offen offset:0 sc1
    buffer_load_dwordx4 v[212:215], v2, s[32:35], s60 offen offset:1024 sc1
    buffer_load_dwordx4 v[216:219], v2, s[32:35], s60 offen offset:2048 sc1
    buffer_load_dwordx4 v[220:223], v2, s[32:35], s60 offen offset:3072 sc1
    s_add_u32 s48, s60, 20480
    buffer_load_dwordx4 v[224:227], v2, s[32:35], s48 offen offset:0 sc1
    s_add_u32 s48, s60, 20480
    buffer_load_dwordx4 v[228:231], v2, s[32:35], s48 offen offset:1024 sc1
    s_add_u32 s48, s60, 20480
    buffer_load_dwordx4 v[232:235], v2, s[32:35], s48 offen offset:2048 sc1
    s_add_u32 s48, s60, 20480
    buffer_load_dwordx4 v[236:239], v2, s[32:35], s48 offen offset:3072 sc1
    s_cmp_lg_u32 s40, 3
    s_cbranch_scc1 L_r2_B
    v_cmp_eq_u32 vcc, s51, v80
    s_mov_b32 s72, 0
    v_and_b32 v9, 15, v1
    v_lshlrev_b32 v9, 2, v9
    s_lshr_b32 s54, s70, 2
    s_lshl_b32 s54, s54, 7
    s_add_u32 s54, s54, 12587008
    s_cmp_eq_u64 vcc, exec
    s_cbranch_scc1 L_rok_B
L_rpoll_B:
    buffer_load_dword v80, v9, s[32:35], s54 offen sc1
    s_waitcnt vmcnt(0)
    v_cmp_eq_u32 vcc, s51, v80
    s_add_u32 s72, s72, 1
    s_cmp_gt_u32 s72, 0x80000
    s_cbranch_scc1 L_rok_B
    s_cmp_eq_u64 vcc, exec
    s_cbranch_scc1 L_rok_B
    s_sleep 4
    s_branch L_rpoll_B
L_rok_B:
    v_lshrrev_b32 v9, 3, v1
    v_mul_u32_u24 v9, 36864, v9
    v_and_b32 v10, 7, v1
    v_lshlrev_b32 v10, 4, v10
    v_add_u32 v9, v9, v10
    s_mul_i32 s54, s70, 1152
    s_lshl_b32 s55, s71, 7
    s_add_u32 s55, s55, s54
    s_add_u32 s55, s55, 10485760
    buffer_load_dwordx4 v[80:83], v9, s[32:35], s55 offen sc1
    s_add_u32 s55, s55, 294912
    buffer_load_dwordx4 v[84:87], v9, s[32:35], s55 offen sc1
    v_and_b32 v10, 15, v1
    v_mul_u32_u24 v10, 36864, v10
    s_lshl_b32 s55, s71, 3
    s_add_u32 s55, s55, s54
    s_add_u32 s55, s55, 10486784
    buffer_load_dwordx2 v[88:89], v10, s[32:35], s55 offen sc1
L_r2_B:
    ds_read_b128 v[16:19], v14 offset:0
    s_waitcnt lgkmcnt(0)
    v_add_f32 v16, v16, v17
    v_add_f32 v18, v18, v19
    v_mov_b32 v22, 0
    v_add_f32 v16, v16, v18
    v_mov_b32 v23, 0
    v_cvt_pk_bf16_f32 v20, v16, v16
    v_and_b32 v17, 0xffff0000, v20
    v_sub_f32 v16, v16, v17
    v_cvt_pk_bf16_f32 v21, v16, 0
    s_nop 1
    v_mfma_f32_32x32x16_bf16 v[64:79], v[20:23], v[32:35], v[64:79]
    s_nop 11
    v_mul_f32 v64, v6, v64
    v_mul_f32 v65, v6, v65
    v_mul_f32 v66, v6, v66
    v_mul_f32 v67, v6, v67
    v_exp_f32 v16, v64
    v_exp_f32 v17, v65
    v_exp_f32 v18, v66
    v_exp_f32 v19, v67
    v_mul_f32 v72, v72, v64
    v_mul_f32 v73, v73, v65
    v_mul_f32 v74, v74, v66
    v_mul_f32 v75, v75, v67
    v_fma_f32 v16, v16, v7, v7
    v_fma_f32 v17, v17, v7, v7
    v_fma_f32 v18, v18, v7, v7
    v_fma_f32 v19, v19, v7, v7
    v_rcp_f32 v16, v16
    v_rcp_f32 v17, v17
    v_rcp_f32 v18, v18
    v_rcp_f32 v19, v19
    v_mul_f32 v64, v72, v16
    v_mul_f32 v65, v73, v17
    v_mul_f32 v66, v74, v18
    v_mul_f32 v67, v75, v19
    v_mul_f32 v68, v6, v68
    v_mul_f32 v69, v6, v69
    v_mul_f32 v70, v6, v70
    v_mul_f32 v71, v6, v71
    v_exp_f32 v16, v68
    v_exp_f32 v17, v69
    v_exp_f32 v18, v70
    v_exp_f32 v19, v71
    v_mul_f32 v76, v76, v68
    v_mul_f32 v77, v77, v69
    v_mul_f32 v78, v78, v70
    v_mul_f32 v79, v79, v71
    v_fma_f32 v16, v16, v7, v7
    v_fma_f32 v17, v17, v7, v7
    v_fma_f32 v18, v18, v7, v7
    v_fma_f32 v19, v19, v7, v7
    v_rcp_f32 v16, v16
    v_rcp_f32 v17, v17
    v_rcp_f32 v18, v18
    v_rcp_f32 v19, v19
    v_mul_f32 v68, v76, v16
    v_mul_f32 v69, v77, v17
    v_mul_f32 v70, v78, v18
    v_mul_f32 v71, v79, v19
    v_cvt_pk_bf16_f32 v64, v64, v65
    v_cvt_pk_bf16_f32 v65, v66, v67
    v_cvt_pk_bf16_f32 v66, v68, v69
    v_cvt_pk_bf16_f32 v67, v70, v71
    s_lshr_b32 s54, s73, 4
    s_mul_i32 s55, s42, 1
    s_add_u32 s54, s54, s55
    s_add_u32 s54, s54, 0
    s_lshl_b32 s54, s54, 10
    s_add_u32 s54, s54, s50
    buffer_store_dwordx4 v[64:67], v2, s[32:35], s54 offen sc1
    v_lshrrev_b32 v0, 2, v1
    v_and_b32 v0, 3, v0
    v_lshrrev_b32 v3, 5, v1
    v_lshlrev_b32 v3, 2, v3
    v_add_u32 v3, v3, v0
    v_lshlrev_b32 v3, 7, v3
    v_lshrrev_b32 v0, 1, v0
    v_lshlrev_b32 v0, 6, v0
    v_add_u32 v3, v3, v0
    v_lshrrev_b32 v0, 4, v1
    v_and_b32 v0, 1, v0
    v_lshlrev_b32 v0, 5, v0
    v_add_u32 v3, v3, v0
    v_and_b32 v0, 3, v1
    v_lshlrev_b32 v0, 3, v0
    v_add_u32 v3, v3, v0
    s_lshl_b32 s52, s78, 12
    v_add_u32 v24, s52, v3
    v_xor_b32 v25, 64, v24
    v_add_u32 v26, 0x10000, v24
    v_add_u32 v27, 0x10000, v25
    v_add_u32 v28, 0x20000, v24
    v_add_u32 v29, 0x20000, v25
    ds_read_b64_tr_b16 v[128:129], v28 offset:0
    ds_read_b64_tr_b16 v[130:131], v28 offset:1024
    ds_read_b64_tr_b16 v[132:133], v29 offset:0
    ds_read_b64_tr_b16 v[134:135], v29 offset:1024
    ds_read_b64_tr_b16 v[136:137], v28 offset:2048
    ds_read_b64_tr_b16 v[138:139], v28 offset:3072
    ds_read_b64_tr_b16 v[140:141], v29 offset:2048
    ds_read_b64_tr_b16 v[142:143], v29 offset:3072
    ds_read_b64_tr_b16 v[144:145], v26 offset:0
    ds_read_b64_tr_b16 v[146:147], v26 offset:1024
    ds_read_b64_tr_b16 v[148:149], v27 offset:0
    ds_read_b64_tr_b16 v[150:151], v27 offset:1024
    ds_read_b64_tr_b16 v[152:153], v26 offset:2048
    ds_read_b64_tr_b16 v[154:155], v26 offset:3072
    ds_read_b64_tr_b16 v[156:157], v27 offset:2048
    ds_read_b64_tr_b16 v[158:159], v27 offset:3072
    ds_read_b64_tr_b16 v[160:161], v26 offset:16384
    ds_read_b64_tr_b16 v[162:163], v26 offset:17408
    ds_read_b64_tr_b16 v[164:165], v27 offset:16384
    ds_read_b64_tr_b16 v[166:167], v27 offset:17408
    ds_read_b64_tr_b16 v[168:169], v26 offset:18432
    ds_read_b64_tr_b16 v[170:171], v26 offset:19456
    ds_read_b64_tr_b16 v[172:173], v27 offset:18432
    ds_read_b64_tr_b16 v[174:175], v27 offset:19456
    ds_read_b64_tr_b16 v[176:177], v26 offset:32768
    ds_read_b64_tr_b16 v[178:179], v26 offset:33792
    ds_read_b64_tr_b16 v[180:181], v27 offset:32768
    ds_read_b64_tr_b16 v[182:183], v27 offset:33792
    ds_read_b64_tr_b16 v[184:185], v26 offset:34816
    ds_read_b64_tr_b16 v[186:187], v26 offset:35840
    ds_read_b64_tr_b16 v[188:189], v27 offset:34816
    ds_read_b64_tr_b16 v[190:191], v27 offset:35840
    ds_read_b64_tr_b16 v[192:193], v26 offset:49152
    ds_read_b64_tr_b16 v[194:195], v26 offset:50176
    ds_read_b64_tr_b16 v[196:197], v27 offset:49152
    ds_read_b64_tr_b16 v[198:199], v27 offset:50176
    ds_read_b64_tr_b16 v[200:201], v26 offset:51200
    ds_read_b64_tr_b16 v[202:203], v26 offset:52224
    ds_read_b64_tr_b16 v[204:205], v27 offset:51200
    ds_read_b64_tr_b16 v[206:207], v27 offset:52224
    s_cmp_lg_u32 s40, 3
    s_cbranch_scc1 L_r3_B
    s_waitcnt vmcnt(1)
    v_add_f32 v80, v80, v84
    v_add_f32 v81, v81, v85
    v_add_f32 v82, v82, v86
    v_add_f32 v83, v83, v87
    v_add_f32_dpp v80, v80, v80 row_ror:8 row_mask:0xf bank_mask:0xf
    v_add_f32_dpp v81, v81, v81 row_ror:8 row_mask:0xf bank_mask:0xf
    v_add_f32_dpp v82, v82, v82 row_ror:8 row_mask:0xf bank_mask:0xf
    v_add_f32_dpp v83, v83, v83 row_ror:8 row_mask:0xf bank_mask:0xf
    s_waitcnt vmcnt(1)
    v_add_f32_dpp v88, v88, v88 quad_perm:[1,0,3,2] row_mask:0xf bank_mask:0xf
    v_add_f32_dpp v89, v89, v89 quad_perm:[1,0,3,2] row_mask:0xf bank_mask:0xf
    s_nop 0
    v_add_f32_dpp v88, v88, v88 quad_perm:[2,3,0,1] row_mask:0xf bank_mask:0xf
    v_add_f32_dpp v89, v89, v89 quad_perm:[2,3,0,1] row_mask:0xf bank_mask:0xf
    s_nop 0
    v_add_f32_dpp v88, v88, v88 row_half_mirror row_mask:0xf bank_mask:0xf
    v_add_f32_dpp v89, v89, v89 row_half_mirror row_mask:0xf bank_mask:0xf
    s_nop 0
    v_add_f32_dpp v88, v88, v88 row_mirror row_mask:0xf bank_mask:0xf
    v_add_f32_dpp v89, v89, v89 row_mirror row_mask:0xf bank_mask:0xf
    v_mov_b32 v90, v80
    v_mov_b32 v91, v81
    v_mov_b32 v92, v82
    v_mov_b32 v93, v83
    v_permlane16_swap_b32 v80, v90
    v_permlane16_swap_b32 v81, v91
    v_permlane16_swap_b32 v82, v92
    v_permlane16_swap_b32 v83, v93
    v_add_f32 v80, v80, v90
    v_add_f32 v81, v81, v91
    v_add_f32 v82, v82, v92
    v_add_f32 v83, v83, v93
    v_mov_b32 v90, v80
    v_mov_b32 v91, v81
    v_mov_b32 v92, v82
    v_mov_b32 v93, v83
    v_permlane32_swap_b32 v80, v90
    v_permlane32_swap_b32 v81, v91
    v_permlane32_swap_b32 v82, v92
    v_permlane32_swap_b32 v83, v93
    v_add_f32 v80, v80, v90
    v_add_f32 v81, v81, v91
    v_add_f32 v82, v82, v92
    v_add_f32 v83, v83, v93
    v_cvt_pk_bf16_f32 v80, v80, v81
    v_cvt_pk_bf16_f32 v81, v82, v83
    v_cvt_pk_bf16_f32 v88, v88, v89
    v_lshlrev_b32 v9, 3, v1
    v_mov_b32 v10, 2130706432
    v_cmp_gt_u32 vcc, 8, v1
    s_mul_i32 s54, s70, 640
    s_add_u32 s54, s54, 11534336
    v_cndmask_b32 v9, v10, v9, vcc
    s_lshl_b32 s55, s71, 6
    s_add_u32 s55, s55, s54
    buffer_store_dwordx2 v[80:81], v9, s[32:35], s55 offen sc1
    v_cmp_eq_u32 vcc, 0, v1
    v_mov_b32 v9, 0
    s_lshl_b32 s55, s71, 2
    s_add_u32 s55, s55, s54
    s_add_u32 s55, s55, 512
    v_cndmask_b32 v9, v10, v9, vcc
    buffer_store_dword v88, v9, s[32:35], s55 offen sc1
L_r3_B:
    v_and_b32 v0, 31, v1
    v_lshlrev_b32 v0, 10, v0
    v_lshrrev_b32 v3, 5, v1
    v_lshlrev_b32 v3, 3, v3
    v_add_u32 v0, v0, v3
    s_lshl_b32 s52, s64, 16
    s_lshl_b32 s53, s79, 15
    s_add_u32 s52, s52, s53
    s_lshl_b32 s53, s65, 7
    s_add_u32 s52, s52, s53
    s_lshl_b32 s53, s78, 5
    s_add_u32 s53, s52, s53
    buffer_load_dwordx2 v[6:7], v0, s[4:7], s53 offen
    buffer_load_dwordx2 v[14:15], v0, s[4:7], s53 offen offset:16
    s_mov_b32 s49, s53
    s_waitcnt vmcnt(10) lgkmcnt(15)
    v_mfma_f32_32x32x16_bf16 v[96:111], v[128:131], v[208:211], 0
    v_mfma_f32_32x32x16_bf16 v[112:127], v[132:135], v[208:211], 0
    s_waitcnt vmcnt(9)
    v_mfma_f32_32x32x16_bf16 v[96:111], v[136:139], v[212:215], v[96:111]
    v_mfma_f32_32x32x16_bf16 v[112:127], v[140:143], v[212:215], v[112:127]
    s_waitcnt vmcnt(8)
    v_mfma_f32_32x32x16_bf16 v[96:111], v[144:147], v[216:219], v[96:111]
    v_mfma_f32_32x32x16_bf16 v[112:127], v[148:151], v[216:219], v[112:127]
    s_waitcnt vmcnt(7)
    v_mfma_f32_32x32x16_bf16 v[96:111], v[152:155], v[220:223], v[96:111]
    v_mfma_f32_32x32x16_bf16 v[112:127], v[156:159], v[220:223], v[112:127]
    s_waitcnt vmcnt(6)
    v_mfma_f32_32x32x16_bf16 v[96:111], v[160:163], v[224:227], v[96:111]
    v_mfma_f32_32x32x16_bf16 v[112:127], v[164:167], v[224:227], v[112:127]
    s_waitcnt vmcnt(5)
    v_mfma_f32_32x32x16_bf16 v[96:111], v[168:171], v[228:231], v[96:111]
    v_mfma_f32_32x32x16_bf16 v[112:127], v[172:175], v[228:231], v[112:127]
    s_waitcnt vmcnt(4) lgkmcnt(14)
    v_mfma_f32_32x32x16_bf16 v[96:111], v[176:179], v[232:235], v[96:111]
    s_waitcnt lgkmcnt(12)
    v_mfma_f32_32x32x16_bf16 v[112:127], v[180:183], v[232:235], v[112:127]
    s_waitcnt vmcnt(3) lgkmcnt(10)
    v_mfma_f32_32x32x16_bf16 v[96:111], v[184:187], v[236:239], v[96:111]
    s_waitcnt lgkmcnt(8)
    v_mfma_f32_32x32x16_bf16 v[112:127], v[188:191], v[236:239], v[112:127]
    s_waitcnt vmcnt(2)
    s_waitcnt lgkmcnt(0)
    s_barrier
    s_cmp_lg_u32 s40, 3
    s_cbranch_scc1 L_r4_B
    v_mov_b32 v3, s51
    v_mov_b32 v4, 0
    s_lshl_b32 s55, s2, 2
    s_add_u32 s55, s55, 12591104
    s_mov_b64 s[68:69], exec
    s_mov_b64 exec, 1
    buffer_store_dword v3, v4, s[32:35], s55 offen sc1
    s_mov_b64 exec, s[68:69]
L_r4_B:
    s_cmp_lg_u32 s40, 0
    s_cbranch_scc1 L_fl_f1bB
    s_lshl_b32 s54, s43, 7
    s_lshl_b32 s55, s44, 2
    s_add_u32 s54, s54, s55
    s_add_u32 s54, s54, 12595200
    v_mov_b32 v9, s51
    v_mov_b32 v10, 0
    s_mov_b64 s[68:69], exec
    s_mov_b64 exec, 1
    buffer_store_dword v9, v10, s[32:35], s54 offen sc1
    s_mov_b64 exec, s[68:69]
L_fl_f1bB:
    s_add_u32 m0, s67, 0
    s_add_u32 s77, s58, 98304
    buffer_load_dwordx4 v5, s[20:23], s77 offen lds
    s_add_u32 s77, s58, 105472
    buffer_load_dwordx4 v5, s[20:23], s77 offen offset:1024 lds
    s_add_u32 m0, s67, 16384
    s_add_u32 s77, s58, 131072
    buffer_load_dwordx4 v5, s[20:23], s77 offen lds
    s_add_u32 s77, s58, 138240
    buffer_load_dwordx4 v5, s[20:23], s77 offen offset:1024 lds
    s_add_u32 m0, s67, 32768
    s_add_u32 s77, s58, 163840
    buffer_load_dwordx4 v5, s[20:23], s77 offen lds
    s_add_u32 s77, s58, 171008
    buffer_load_dwordx4 v5, s[20:23], s77 offen offset:1024 lds
    s_add_u32 m0, s67, 49152
    s_add_u32 s77, s58, 196608
    buffer_load_dwordx4 v5, s[20:23], s77 offen lds
    s_add_u32 s77, s58, 203776
    buffer_load_dwordx4 v5, s[20:23], s77 offen offset:1024 lds
    s_add_u32 m0, s67, 147456
    s_add_u32 s77, s58, 229376
    buffer_load_dwordx4 v5, s[20:23], s77 offen lds
    s_add_u32 s77, s58, 236544
    buffer_load_dwordx4 v5, s[20:23], s77 offen offset:1024 lds
    s_add_u32 m0, s67, 131072
    s_add_u32 s77, s58, 262144
    buffer_load_dwordx4 v5, s[20:23], s77 offen lds
    s_add_u32 s77, s58, 269312
    buffer_load_dwordx4 v5, s[20:23], s77 offen offset:1024 lds
    s_add_u32 m0, s67, 65536
    s_add_u32 s77, s58, 294912
    buffer_load_dwordx4 v5, s[20:23], s77 offen lds
    s_add_u32 s77, s58, 302080
    buffer_load_dwordx4 v5, s[20:23], s77 offen offset:1024 lds
    s_add_u32 m0, s67, 81920
    s_add_u32 s77, s59, 0
    buffer_load_dwordx4 v5, s[24:27], s77 offen lds
    s_add_u32 s77, s59, 7168
    buffer_load_dwordx4 v5, s[24:27], s77 offen offset:1024 lds
    s_add_u32 m0, s67, 98304
    s_add_u32 s77, s59, 32768
    buffer_load_dwordx4 v5, s[24:27], s77 offen lds
    s_add_u32 s77, s59, 39936
    buffer_load_dwordx4 v5, s[24:27], s77 offen offset:1024 lds
    s_cmp_lg_u32 s40, 4
    s_cbranch_scc1 L_tr2_B
    v_and_b32 v0, 15, v1
    v_lshlrev_b32 v0, 2, v0
    s_lshr_b32 s54, s64, 1
    s_lshl_b32 s54, s54, 7
    s_add_u32 s54, s54, 12595200
    s_mov_b32 s72, 0
L_pf1b_B:
    buffer_load_dword v3, v0, s[32:35], s54 offen sc1
    s_waitcnt vmcnt(0)
    v_cmp_eq_u32 vcc, s51, v3
    s_add_u32 s72, s72, 1
    s_cmp_gt_u32 s72, 0x80000
    s_cbranch_scc1 L_tr2_B
    s_cmp_eq_u64 vcc, exec
    s_cbranch_scc1 L_tr2_B
    s_sleep 4
    s_branch L_pf1b_B
L_tr2_B:
    s_barrier
    s_add_u32 s48, s60, 4096
    buffer_load_dwordx4 v[240:243], v2, s[32:35], s48 offen offset:0 sc1
    s_add_u32 s48, s60, 4096
    buffer_load_dwordx4 v[244:247], v2, s[32:35], s48 offen offset:1024 sc1
    s_add_u32 s48, s60, 4096
    buffer_load_dwordx4 v[248:251], v2, s[32:35], s48 offen offset:2048 sc1
    s_add_u32 s48, s60, 4096
    buffer_load_dwordx4 v[252:255], v2, s[32:35], s48 offen offset:3072 sc1
    s_add_u32 s48, s60, 8192
    buffer_load_dwordx4 v[64:67], v2, s[32:35], s48 offen offset:0 sc1
    s_add_u32 s48, s60, 8192
    buffer_load_dwordx4 v[68:71], v2, s[32:35], s48 offen offset:1024 sc1
    s_add_u32 s48, s60, 8192
    buffer_load_dwordx4 v[72:75], v2, s[32:35], s48 offen offset:2048 sc1
    s_add_u32 s48, s60, 8192
    buffer_load_dwordx4 v[76:79], v2, s[32:35], s48 offen offset:3072 sc1
    s_add_u32 s48, s60, 12288
    buffer_load_dwordx4 v[128:131], v2, s[32:35], s48 offen offset:0 sc1
    s_add_u32 s48, s60, 12288
    buffer_load_dwordx4 v[132:135], v2, s[32:35], s48 offen offset:1024 sc1
    s_add_u32 s48, s60, 12288
    buffer_load_dwordx4 v[208:211], v2, s[32:35], s48 offen offset:2048 sc1
    s_add_u32 s48, s60, 12288
    buffer_load_dwordx4 v[136:139], v2, s[32:35], s48 offen offset:3072 sc1
    s_waitcnt vmcnt(11)
    v_mfma_f32_32x32x16_bf16 v[96:111], v[192:195], v[240:243], v[96:111]
    v_mfma_f32_32x32x16_bf16 v[112:127], v[196:199], v[240:243], v[112:127]
    s_add_u32 s48, s60, 16384
    buffer_load_dwordx4 v[140:143], v2, s[32:35], s48 offen offset:0 sc1
    s_barrier
    ds_read_b64_tr_b16 v[48:49], v24 offset:0
    ds_read_b64_tr_b16 v[50:51], v24 offset:1024
    s_waitcnt vmcnt(11)
    v_mfma_f32_32x32x16_bf16 v[96:111], v[200:203], v[244:247], v[96:111]
    s_add_u32 m0, s67, 114688
    s_add_u32 s77, s59, 65536
    buffer_load_dwordx4 v5, s[24:27], s77 offen lds
    ds_read_b64_tr_b16 v[52:53], v25 offset:0
    ds_read_b64_tr_b16 v[54:55], v25 offset:1024
    v_mfma_f32_32x32x16_bf16 v[112:127], v[204:207], v[244:247], v[112:127]
    s_add_u32 s48, s60, 16384
    buffer_load_dwordx4 v[212:215], v2, s[32:35], s48 offen offset:1024 sc1
    s_add_u32 s77, s59, 72704
    buffer_load_dwordx4 v5, s[24:27], s77 offen offset:1024 lds
    ds_read_b64_tr_b16 v[56:57], v24 offset:2048
    ds_read_b64_tr_b16 v[58:59], v24 offset:3072
    s_waitcnt vmcnt(13) lgkmcnt(4)
    v_mfma_f32_32x32x16_bf16 v[96:111], v[48:51], v[248:251], v[96:111]
    ds_read_b64_tr_b16 v[60:61], v25 offset:2048
    ds_read_b64_tr_b16 v[62:63], v25 offset:3072
    s_waitcnt lgkmcnt(4)
    v_mfma_f32_32x32x16_bf16 v[112:127], v[52:55], v[248:251], v[112:127]
    s_add_u32 s48, s60, 16384
    buffer_load_dwordx4 v[144:147], v2, s[32:35], s48 offen offset:2048 sc1
    ds_read_b64_tr_b16 v[48:49], v24 offset:16384
    ds_read_b64_tr_b16 v[50:51], v24 offset:17408
    s_waitcnt vmcnt(13) lgkmcnt(4)
    v_mfma_f32_32x32x16_bf16 v[96:111], v[56:59], v[252:255], v[96:111]
    ds_read_b64_tr_b16 v[52:53], v25 offset:16384
    ds_read_b64_tr_b16 v[54:55], v25 offset:17408
    s_waitcnt lgkmcnt(4)
    v_mfma_f32_32x32x16_bf16 v[112:127], v[60:63], v[252:255], v[112:127]
    s_add_u32 s48, s60, 16384
    buffer_load_dwordx4 v[148:151], v2, s[32:35], s48 offen offset:3072 sc1
    ds_read_b64_tr_b16 v[56:57], v24 offset:18432
    ds_read_b64_tr_b16 v[58:59], v24 offset:19456
    s_waitcnt vmcnt(13) lgkmcnt(4)
    v_mfma_f32_32x32x16_bf16 v[96:111], v[48:51], v[64:67], v[96:111]
    ds_read_b64_tr_b16 v[60:61], v25 offset:18432
    ds_read_b64_tr_b16 v[62:63], v25 offset:19456
    s_waitcnt lgkmcnt(4)
    v_mfma_f32_32x32x16_bf16 v[112:127], v[52:55], v[64:67], v[112:127]
    buffer_load_dwordx4 v[216:219], v2, s[32:35], s61 offen offset:0 sc1
    ds_read_b64_tr_b16 v[48:49], v24 offset:32768
    ds_read_b64_tr_b16 v[50:51], v24 offset:33792
    s_waitcnt vmcnt(13) lgkmcnt(4)
    v_mfma_f32_32x32x16_bf16 v[96:111], v[56:59], v[68:71], v[96:111]
    ds_read_b64_tr_b16 v[52:53], v25 offset:32768
    ds_read_b64_tr_b16 v[54:55], v25 offset:33792
    s_waitcnt lgkmcnt(4)
    v_mfma_f32_32x32x16_bf16 v[112:127], v[60:63], v[68:71], v[112:127]
    buffer_load_dwordx4 v[152:155], v2, s[32:35], s61 offen offset:1024 sc1
    ds_read_b64_tr_b16 v[56:57], v24 offset:34816
    ds_read_b64_tr_b16 v[58:59], v24 offset:35840
    s_waitcnt vmcnt(13) lgkmcnt(4)
    v_mfma_f32_32x32x16_bf16 v[96:111], v[48:51], v[72:75], v[96:111]
    ds_read_b64_tr_b16 v[60:61], v25 offset:34816
    ds_read_b64_tr_b16 v[62:63], v25 offset:35840
    s_waitcnt lgkmcnt(4)
    v_mfma_f32_32x32x16_bf16 v[112:127], v[52:55], v[72:75], v[112:127]
    buffer_load_dwordx4 v[156:159], v2, s[32:35], s61 offen offset:2048 sc1
    ds_read_b64_tr_b16 v[48:49], v24 offset:49152
    ds_read_b64_tr_b16 v[50:51], v24 offset:50176
    s_waitcnt vmcnt(13) lgkmcnt(4)
    v_mfma_f32_32x32x16_bf16 v[96:111], v[56:59], v[76:79], v[96:111]
    ds_read_b64_tr_b16 v[52:53], v25 offset:49152
    ds_read_b64_tr_b16 v[54:55], v25 offset:50176
    s_waitcnt lgkmcnt(4)
    v_mfma_f32_32x32x16_bf16 v[112:127], v[60:63], v[76:79], v[112:127]
    buffer_load_dwordx4 v[220:223], v2, s[32:35], s61 offen offset:3072 sc1
    ds_read_b64_tr_b16 v[56:57], v24 offset:51200
    ds_read_b64_tr_b16 v[58:59], v24 offset:52224
    s_cmp_lg_u32 s40, 6
    s_cbranch_scc1 L_f3i_B
    v_lshlrev_b32 v0, 4, v1
    v_add_u32 v0, 12591104, v0
    buffer_load_dwordx4 v[16:19], v0, s[32:35], 0 offen sc1
L_f3i_B:
    s_waitcnt vmcnt(13) lgkmcnt(4)
    v_mfma_f32_32x32x16_bf16 v[96:111], v[48:51], v[128:131], v[96:111]
    ds_read_b64_tr_b16 v[60:61], v25 offset:51200
    ds_read_b64_tr_b16 v[62:63], v25 offset:52224
    s_waitcnt lgkmcnt(4)
    v_mfma_f32_32x32x16_bf16 v[112:127], v[52:55], v[128:131], v[112:127]
    s_add_u32 s48, s61, 4096
    buffer_load_dwordx4 v[160:163], v2, s[32:35], s48 offen offset:0 sc1
    s_cmp_lg_u32 s40, 6
    s_cbranch_scc1 L_f3ok_B
    s_waitcnt vmcnt(1)
    v_cmp_eq_u32 vcc, s51, v16
    v_cmp_eq_u32 s[68:69], s51, v17
    s_nop 1
    s_and_b64 vcc, vcc, s[68:69]
    v_cmp_eq_u32 s[68:69], s51, v18
    s_nop 1
    s_and_b64 vcc, vcc, s[68:69]
    v_cmp_eq_u32 s[68:69], s51, v19
    s_nop 1
    s_and_b64 vcc, vcc, s[68:69]
    s_mov_b32 s72, 0
    s_cmp_eq_u64 vcc, exec
    s_cbranch_scc1 L_f3ok_B
    v_lshlrev_b32 v0, 4, v1
    v_add_u32 v0, 12591104, v0
L_f3l_B:
    buffer_load_dwordx4 v[16:19], v0, s[32:35], 0 offen sc1
    s_waitcnt vmcnt(0)
    v_cmp_eq_u32 vcc, s51, v16
    v_cmp_eq_u32 s[68:69], s51, v17
    s_nop 1
    s_and_b64 vcc, vcc, s[68:69]
    v_cmp_eq_u32 s[68:69], s51, v18
    s_nop 1
    s_and_b64 vcc, vcc, s[68:69]
    v_cmp_eq_u32 s[68:69], s51, v19
    s_nop 1
    s_and_b64 vcc, vcc, s[68:69]
    s_add_u32 s72, s72, 1
    s_cmp_gt_u32 s72, 0x80000
    s_cbranch_scc1 L_f3ok_B
    s_cmp_eq_u64 vcc, exec
    s_cbranch_scc1 L_f3ok_B
    s_sleep 4
    s_branch L_f3l_B
L_f3ok_B:
    s_barrier
    v_and_b32 v0, 31, v1
    v_lshlrev_b32 v3, 5, v0
    v_mov_b32 v4, 2130706432
    v_cmp_gt_u32 vcc, 16, v0
    v_and_b32 v80, 27, v0
    s_nop 0
    v_cndmask_b32 v3, v4, v3, vcc
    v_cmp_eq_u32 vcc, 16, v80
    v_mov_b32 v4, 512
    v_lshrrev_b32 v0, 5, v1
    v_cndmask_b32 v3, v3, v4, vcc
    v_lshlrev_b32 v0, 4, v0
    v_add_u32 v3, v3, v0
    s_mul_i32 s53, s78, 5120
    s_add_u32 s53, s53, 11534336
    buffer_load_dwordx4 v[164:167], v3, s[32:35], s53 offen offset:0 sc1
    buffer_load_dwordx4 v[224:227], v3, s[32:35], s53 offen offset:640 sc1
    buffer_load_dwordx4 v[168:171], v3, s[32:35], s53 offen offset:1280 sc1
    buffer_load_dwordx4 v[172:175], v3, s[32:35], s53 offen offset:1920 sc1
    buffer_load_dwordx4 v[228:231], v3, s[32:35], s53 offen offset:2560 sc1
    buffer_load_dwordx4 v[176:179], v3, s[32:35], s53 offen offset:3200 sc1
    buffer_load_dwordx4 v[180:183], v3, s[32:35], s53 offen offset:3840 sc1
    s_add_u32 s53, s53, 4480
    buffer_load_dwordx4 v[232:235], v3, s[32:35], s53 offen sc1
    ds_read_b64_tr_b16 v[48:49], v28 offset:16384
    ds_read_b64_tr_b16 v[50:51], v28 offset:17408
    s_waitcnt vmcnt(21) lgkmcnt(4)
    v_mfma_f32_32x32x16_bf16 v[96:111], v[56:59], v[132:135], v[96:111]
    s_add_u32 m0, s67, 0
    s_add_u32 s77, s59, 98304
    buffer_load_dwordx4 v5, s[24:27], s77 offen lds
    ds_read_b64_tr_b16 v[52:53], v29 offset:16384
    ds_read_b64_tr_b16 v[54:55], v29 offset:17408
    s_waitcnt lgkmcnt(4)
    v_mfma_f32_32x32x16_bf16 v[112:127], v[60:63], v[132:135], v[112:127]
    s_add_u32 s48, s61, 4096
    buffer_load_dwordx4 v[184:187], v2, s[32:35], s48 offen offset:1024 sc1
    s_add_u32 s77, s59, 105472
    buffer_load_dwordx4 v5, s[24:27], s77 offen offset:1024 lds
    s_add_u32 m0, s67, 16384
    ds_read_b64_tr_b16 v[56:57], v28 offset:18432
    ds_read_b64_tr_b16 v[58:59], v28 offset:19456
    s_waitcnt vmcnt(23) lgkmcnt(4)
    v_mfma_f32_32x32x16_bf16 v[96:111], v[48:51], v[208:211], v[96:111]
    s_add_u32 s77, s58, 393216
    buffer_load_dwordx4 v5, s[20:23], s77 offen lds
    s_add_u32 s77, s58, 400384
    ds_read_b64_tr_b16 v[60:61], v29 offset:18432
    ds_read_b64_tr_b16 v[62:63], v29 offset:19456
    s_waitcnt lgkmcnt(4)
    v_mfma_f32_32x32x16_bf16 v[112:127], v[52:55], v[208:211], v[112:127]
    s_add_u32 s48, s61, 4096
    buffer_load_dwordx4 v[188:191], v2, s[32:35], s48 offen offset:2048 sc1
    buffer_load_dwordx4 v5, s[20:23], s77 offen offset:1024 lds
    s_add_u32 m0, s67, 32768
    s_add_u32 s77, s58, 425984
    buffer_load_dwordx4 v5, s[20:23], s77 offen lds
    s_add_u32 s77, s58, 433152
    buffer_load_dwordx4 v5, s[20:23], s77 offen offset:1024 lds
    s_waitcnt vmcnt(23)
    s_barrier
    ds_read_b64_tr_b16 v[48:49], v28 offset:0
    ds_read_b64_tr_b16 v[50:51], v28 offset:1024
    s_waitcnt lgkmcnt(4)
    v_mfma_f32_32x32x16_bf16 v[96:111], v[56:59], v[136:139], v[96:111]
    ds_read_b64_tr_b16 v[52:53], v29 offset:0
    ds_read_b64_tr_b16 v[54:55], v29 offset:1024
    s_waitcnt lgkmcnt(4)
    v_mfma_f32_32x32x16_bf16 v[112:127], v[60:63], v[136:139], v[112:127]
    s_add_u32 s48, s61, 4096
    buffer_load_dwordx4 v[236:239], v2, s[32:35], s48 offen offset:3072 sc1
    ds_read_b64_tr_b16 v[56:57], v28 offset:2048
    ds_read_b64_tr_b16 v[58:59], v28 offset:3072
    s_waitcnt lgkmcnt(4)
    v_mfma_f32_32x32x16_bf16 v[96:111], v[48:51], v[140:143], v[96:111]
    ds_read_b64_tr_b16 v[60:61], v29 offset:2048
    ds_read_b64_tr_b16 v[62:63], v29 offset:3072
    s_waitcnt lgkmcnt(4)
    v_mfma_f32_32x32x16_bf16 v[112:127], v[52:55], v[140:143], v[112:127]
    s_add_u32 s48, s60, 24576
    buffer_load_dwordx4 v[192:195], v2, s[32:35], s48 offen offset:0 sc1
    ds_read_b64_tr_b16 v[48:49], v26 offset:0
    ds_read_b64_tr_b16 v[50:51], v26 offset:1024
    s_waitcnt lgkmcnt(4)
    v_mfma_f32_32x32x16_bf16 v[96:111], v[56:59], v[212:215], v[96:111]
    ds_read_b64_tr_b16 v[52:53], v27 offset:0
    ds_read_b64_tr_b16 v[54:55], v27 offset:1024
    s_waitcnt lgkmcnt(4)
    v_mfma_f32_32x32x16_bf16 v[112:127], v[60:63], v[212:215], v[112:127]
    s_add_u32 s48, s60, 24576
    buffer_load_dwordx4 v[196:199], v2, s[32:35], s48 offen offset:1024 sc1
    ds_read_b64_tr_b16 v[56:57], v26 offset:2048
    ds_read_b64_tr_b16 v[58:59], v26 offset:3072
    s_waitcnt vmcnt(25) lgkmcnt(4)
    v_mfma_f32_32x32x16_bf16 v[96:111], v[48:51], v[144:147], v[96:111]
    ds_read_b64_tr_b16 v[60:61], v27 offset:2048
    ds_read_b64_tr_b16 v[62:63], v27 offset:3072
    s_waitcnt lgkmcnt(4)
    v_mfma_f32_32x32x16_bf16 v[112:127], v[52:55], v[144:147], v[112:127]
    s_add_u32 s48, s60, 24576
    buffer_load_dwordx4 v[240:243], v2, s[32:35], s48 offen offset:2048 sc1
    ds_read_b64_tr_b16 v[48:49], v26 offset:16384
    ds_read_b64_tr_b16 v[50:51], v26 offset:17408
    s_waitcnt vmcnt(19)
    v_mfma_f32_32x32x16_bf16 v[80:95], v[164:167], v[216:219], 0
    s_waitcnt lgkmcnt(4)
    v_mfma_f32_32x32x16_bf16 v[96:111], v[56:59], v[148:151], v[96:111]
    ds_read_b64_tr_b16 v[52:53], v27 offset:16384
    ds_read_b64_tr_b16 v[54:55], v27 offset:17408
    s_waitcnt lgkmcnt(4)
    v_mfma_f32_32x32x16_bf16 v[112:127], v[60:63], v[148:151], v[112:127]
    s_add_u32 s48, s60, 24576
    buffer_load_dwordx4 v[200:203], v2, s[32:35], s48 offen offset:3072 sc1
    ds_read_b64_tr_b16 v[56:57], v26 offset:18432
    ds_read_b64_tr_b16 v[58:59], v26 offset:19456
    s_nop 1
    v_add_f32 v88, 0x358637bd, v88
    v_rcp_f32 v88, v88
    s_nop 0
    v_mul_f32 v80, v80, v88
    v_mul_f32 v81, v81, v88
    v_mul_f32 v82, v82, v88
    v_mul_f32 v83, v83, v88
    v_mul_f32 v84, v84, v88
    v_mul_f32 v85, v85, v88
    v_mul_f32 v86, v86, v88
    v_mul_f32 v87, v87, v88
    v_cvt_pk_bf16_f32 v216, v80, v81
    v_cvt_pk_bf16_f32 v217, v82, v83
    v_cvt_pk_bf16_f32 v218, v84, v85
    v_cvt_pk_bf16_f32 v219, v86, v87
    s_waitcnt vmcnt(19)
    v_mfma_f32_32x32x16_bf16 v[80:95], v[224:227], v[152:155], 0
    s_waitcnt lgkmcnt(4)
    v_mfma_f32_32x32x16_bf16 v[96:111], v[48:51], v[216:219], v[96:111]
    ds_read_b64_tr_b16 v[60:61], v27 offset:18432
    ds_read_b64_tr_b16 v[62:63], v27 offset:19456
    s_waitcnt lgkmcnt(4)
    v_mfma_f32_32x32x16_bf16 v[112:127], v[52:55], v[216:219], v[112:127]
    ds_read_b64_tr_b16 v[48:49], v26 offset:32768
    ds_read_b64_tr_b16 v[50:51], v26 offset:33792
    s_nop 3
    v_add_f32 v88, 0x358637bd, v88
    v_rcp_f32 v88, v88
    s_nop 0
    v_mul_f32 v80, v80, v88
    v_mul_f32 v81, v81, v88
    v_mul_f32 v82, v82, v88
    v_mul_f32 v83, v83, v88
    v_mul_f32 v84, v84, v88
    v_mul_f32 v85, v85, v88
    v_mul_f32 v86, v86, v88
    v_mul_f32 v87, v87, v88
    v_cvt_pk_bf16_f32 v152, v80, v81
    v_cvt_pk_bf16_f32 v153, v82, v83
    v_cvt_pk_bf16_f32 v154, v84, v85
    v_cvt_pk_bf16_f32 v155, v86, v87
    s_waitcnt vmcnt(18)
    v_mfma_f32_32x32x16_bf16 v[80:95], v[168:171], v[156:159], 0
    s_waitcnt lgkmcnt(4)
    v_mfma_f32_32x32x16_bf16 v[96:111], v[56:59], v[152:155], v[96:111]
    ds_read_b64_tr_b16 v[52:53], v27 offset:32768
    ds_read_b64_tr_b16 v[54:55], v27 offset:33792
    s_waitcnt lgkmcnt(4)
    v_mfma_f32_32x32x16_bf16 v[112:127], v[60:63], v[152:155], v[112:127]
    ds_read_b64_tr_b16 v[56:57], v26 offset:34816
    ds_read_b64_tr_b16 v[58:59], v26 offset:35840
    s_nop 3
    v_add_f32 v88, 0x358637bd, v88
    v_rcp_f32 v88, v88
    s_nop 0
    v_mul_f32 v80, v80, v88
    v_mul_f32 v81, v81, v88
    v_mul_f32 v82, v82, v88
    v_mul_f32 v83, v83, v88
    v_mul_f32 v84, v84, v88
    v_mul_f32 v85, v85, v88
    v_mul_f32 v86, v86, v88
    v_mul_f32 v87, v87, v88
    v_cvt_pk_bf16_f32 v156, v80, v81
    v_cvt_pk_bf16_f32 v157, v82, v83
    v_cvt_pk_bf16_f32 v158, v84, v85
    v_cvt_pk_bf16_f32 v159, v86, v87
    s_waitcnt vmcnt(17)
    v_mfma_f32_32x32x16_bf16 v[80:95], v[172:175], v[220:223], 0
    s_waitcnt lgkmcnt(4)
    v_mfma_f32_32x32x16_bf16 v[96:111], v[48:51], v[156:159], v[96:111]
    ds_read_b64_tr_b16 v[60:61], v27 offset:34816
    ds_read_b64_tr_b16 v[62:63], v27 offset:35840
    s_waitcnt lgkmcnt(4)
    v_mfma_f32_32x32x16_bf16 v[112:127], v[52:55], v[156:159], v[112:127]
    ds_read_b64_tr_b16 v[48:49], v26 offset:49152
    ds_read_b64_tr_b16 v[50:51], v26 offset:50176
    s_nop 3
    v_add_f32 v88, 0x358637bd, v88
    v_rcp_f32 v88, v88
    s_nop 0
    v_mul_f32 v80, v80, v88
    v_mul_f32 v81, v81, v88
    v_mul_f32 v82, v82, v88
    v_mul_f32 v83, v83, v88
    v_mul_f32 v84, v84, v88
    v_mul_f32 v85, v85, v88
    v_mul_f32 v86, v86, v88
    v_mul_f32 v87, v87, v88
    v_cvt_pk_bf16_f32 v220, v80, v81
    v_cvt_pk_bf16_f32 v221, v82, v83
    v_cvt_pk_bf16_f32 v222, v84, v85
    v_cvt_pk_bf16_f32 v223, v86, v87
    s_waitcnt vmcnt(16)
    v_mfma_f32_32x32x16_bf16 v[80:95], v[228:231], v[160:163], 0
    s_waitcnt lgkmcnt(4)
    v_mfma_f32_32x32x16_bf16 v[96:111], v[56:59], v[220:223], v[96:111]
    ds_read_b64_tr_b16 v[52:53], v27 offset:49152
    ds_read_b64_tr_b16 v[54:55], v27 offset:50176
    s_waitcnt lgkmcnt(4)
    v_mfma_f32_32x32x16_bf16 v[112:127], v[60:63], v[220:223], v[112:127]
    ds_read_b64_tr_b16 v[56:57], v26 offset:51200
    ds_read_b64_tr_b16 v[58:59], v26 offset:52224
    s_nop 3
    v_add_f32 v88, 0x358637bd, v88
    v_rcp_f32 v88, v88
    s_nop 0
    v_mul_f32 v80, v80, v88
    v_mul_f32 v81, v81, v88
    v_mul_f32 v82, v82, v88
    v_mul_f32 v83, v83, v88
    v_mul_f32 v84, v84, v88
    v_mul_f32 v85, v85, v88
    v_mul_f32 v86, v86, v88
    v_mul_f32 v87, v87, v88
    v_cvt_pk_bf16_f32 v160, v80, v81
    v_cvt_pk_bf16_f32 v161, v82, v83
    v_cvt_pk_bf16_f32 v162, v84, v85
    v_cvt_pk_bf16_f32 v163, v86, v87
    s_waitcnt vmcnt(11)
    v_mfma_f32_32x32x16_bf16 v[80:95], v[176:179], v[184:187], 0
    s_waitcnt lgkmcnt(4)
    v_mfma_f32_32x32x16_bf16 v[96:111], v[48:51], v[160:163], v[96:111]
    ds_read_b64_tr_b16 v[60:61], v27 offset:51200
    ds_read_b64_tr_b16 v[62:63], v27 offset:52224
    s_waitcnt lgkmcnt(4)
    v_mfma_f32_32x32x16_bf16 v[112:127], v[52:55], v[160:163], v[112:127]
    s_waitcnt vmcnt(5)
    s_barrier
    ds_read_b64_tr_b16 v[48:49], v24 offset:0
    ds_read_b64_tr_b16 v[50:51], v24 offset:1024
    s_nop 1
    v_add_f32 v88, 0x358637bd, v88
    v_rcp_f32 v88, v88
    s_nop 0
    v_mul_f32 v80, v80, v88
    v_mul_f32 v81, v81, v88
    v_mul_f32 v82, v82, v88
    v_mul_f32 v83, v83, v88
    v_mul_f32 v84, v84, v88
    v_mul_f32 v85, v85, v88
    v_mul_f32 v86, v86, v88
    v_mul_f32 v87, v87, v88
    v_cvt_pk_bf16_f32 v184, v80, v81
    v_cvt_pk_bf16_f32 v185, v82, v83
    v_cvt_pk_bf16_f32 v186, v84, v85
    v_cvt_pk_bf16_f32 v187, v86, v87
    v_mfma_f32_32x32x16_bf16 v[80:95], v[180:183], v[188:191], 0
    s_waitcnt lgkmcnt(4)
    v_mfma_f32_32x32x16_bf16 v[96:111], v[56:59], v[184:187], v[96:111]
    ds_read_b64_tr_b16 v[52:53], v25 offset:0
    ds_read_b64_tr_b16 v[54:55], v25 offset:1024
    s_waitcnt lgkmcnt(4)
    v_mfma_f32_32x32x16_bf16 v[112:127], v[60:63], v[184:187], v[112:127]
    ds_read_b64_tr_b16 v[56:57], v24 offset:2048
    ds_read_b64_tr_b16 v[58:59], v24 offset:3072
    s_nop 3
    v_add_f32 v88, 0x358637bd, v88
    v_rcp_f32 v88, v88
    s_nop 0
    v_mul_f32 v80, v80, v88
    v_mul_f32 v81, v81, v88
    v_mul_f32 v82, v82, v88
    v_mul_f32 v83, v83, v88
    v_mul_f32 v84, v84, v88
    v_mul_f32 v85, v85, v88
    v_mul_f32 v86, v86, v88
    v_mul_f32 v87, v87, v88
    v_cvt_pk_bf16_f32 v188, v80, v81
    v_cvt_pk_bf16_f32 v189, v82, v83
    v_cvt_pk_bf16_f32 v190, v84, v85
    v_cvt_pk_bf16_f32 v191, v86, v87
    s_waitcnt vmcnt(4)
    v_mfma_f32_32x32x16_bf16 v[80:95], v[232:235], v[236:239], 0
    s_waitcnt lgkmcnt(4)
    v_mfma_f32_32x32x16_bf16 v[96:111], v[48:51], v[188:191], v[96:111]
    ds_read_b64_tr_b16 v[60:61], v25 offset:2048
    ds_read_b64_tr_b16 v[62:63], v25 offset:3072
    s_waitcnt lgkmcnt(4)
    v_mfma_f32_32x32x16_bf16 v[112:127], v[52:55], v[188:191], v[112:127]
    ds_read_b64_tr_b16 v[48:49], v24 offset:16384
    ds_read_b64_tr_b16 v[50:51], v24 offset:17408
    s_nop 3
    v_add_f32 v88, 0x358637bd, v88
    v_rcp_f32 v88, v88
    s_nop 0
    v_mul_f32 v80, v80, v88
    v_mul_f32 v81, v81, v88
    v_mul_f32 v82, v82, v88
    v_mul_f32 v83, v83, v88
    v_mul_f32 v84, v84, v88
    v_mul_f32 v85, v85, v88
    v_mul_f32 v86, v86, v88
    v_mul_f32 v87, v87, v88
    v_cvt_pk_bf16_f32 v236, v80, v81
    v_cvt_pk_bf16_f32 v237, v82, v83
    v_cvt_pk_bf16_f32 v238, v84, v85
    v_cvt_pk_bf16_f32 v239, v86, v87
    s_waitcnt lgkmcnt(4)
    s_nop 0
    v_mfma_f32_32x32x16_bf16 v[96:111], v[56:59], v[236:239], v[96:111]
    ds_read_b64_tr_b16 v[52:53], v25 offset:16384
    ds_read_b64_tr_b16 v[54:55], v25 offset:17408
    s_waitcnt lgkmcnt(4)
    v_mfma_f32_32x32x16_bf16 v[112:127], v[60:63], v[236:239], v[112:127]
    ds_read_b64_tr_b16 v[56:57], v24 offset:18432
    ds_read_b64_tr_b16 v[58:59], v24 offset:19456
    s_waitcnt vmcnt(3) lgkmcnt(4)
    v_mfma_f32_32x32x16_bf16 v[96:111], v[48:51], v[192:195], v[96:111]
    ds_read_b64_tr_b16 v[60:61], v25 offset:18432
    ds_read_b64_tr_b16 v[62:63], v25 offset:19456
    s_waitcnt lgkmcnt(4)
    v_mfma_f32_32x32x16_bf16 v[112:127], v[52:55], v[192:195], v[112:127]
    ds_read_b64_tr_b16 v[48:49], v24 offset:32768
    ds_read_b64_tr_b16 v[50:51], v24 offset:33792
    s_waitcnt vmcnt(2) lgkmcnt(4)
    v_mfma_f32_32x32x16_bf16 v[96:111], v[56:59], v[196:199], v[96:111]
    ds_read_b64_tr_b16 v[52:53], v25 offset:32768
    ds_read_b64_tr_b16 v[54:55], v25 offset:33792
    s_waitcnt lgkmcnt(4)
    v_mfma_f32_32x32x16_bf16 v[112:127], v[60:63], v[196:199], v[112:127]
    ds_read_b64_tr_b16 v[56:57], v24 offset:34816
    ds_read_b64_tr_b16 v[58:59], v24 offset:35840
    s_waitcnt vmcnt(1) lgkmcnt(4)
    v_mfma_f32_32x32x16_bf16 v[96:111], v[48:51], v[240:243], v[96:111]
    ds_read_b64_tr_b16 v[60:61], v25 offset:34816
    ds_read_b64_tr_b16 v[62:63], v25 offset:35840
    s_waitcnt lgkmcnt(4)
    v_mfma_f32_32x32x16_bf16 v[112:127], v[52:55], v[240:243], v[112:127]
    s_waitcnt vmcnt(0) lgkmcnt(2)
    v_mfma_f32_32x32x16_bf16 v[96:111], v[56:59], v[200:203], v[96:111]
    s_waitcnt lgkmcnt(0)
    v_mfma_f32_32x32x16_bf16 v[112:127], v[60:63], v[200:203], v[112:127]
    s_waitcnt lgkmcnt(0)
    s_barrier
    s_lshl_b32 s52, s79, 15
    s_lshl_b32 s53, s78, 11
    s_add_u32 s52, s52, s53
    v_add_u32 v0, s52, v2
    s_cmp_lg_u32 s78, 0
    s_cbranch_scc1 L_rw0_B
    s_nop 1
    ds_write_b128 v0, v[104:107] offset:8192
    ds_write_b128 v0, v[108:111] offset:9216
    ds_write_b128 v0, v[112:115] offset:16384
    ds_write_b128 v0, v[116:119] offset:17408
    ds_write_b128 v0, v[120:123] offset:24576
    ds_write_b128 v0, v[124:127] offset:25600
    v_mov_b32 v128, v96
    v_mov_b32 v129, v97
    v_mov_b32 v130, v98
    v_mov_b32 v131, v99
    v_mov_b32 v132, v100
    v_mov_b32 v133, v101
    v_mov_b32 v134, v102
    v_mov_b32 v135, v103
L_rw0_B:
    s_cmp_lg_u32 s78, 1
    s_cbranch_scc1 L_rw1_B
    ds_write_b128 v0, v[96:99] offset:0
    ds_write_b128 v0, v[100:103] offset:1024
    ds_write_b128 v0, v[112:115] offset:16384
    ds_write_b128 v0, v[116:119] offset:17408
    ds_write_b128 v0, v[120:123] offset:24576
    ds_write_b128 v0, v[124:127] offset:25600
    v_mov_b32 v128, v104
    v_mov_b32 v129, v105
    v_mov_b32 v130, v106
    v_mov_b32 v131, v107
    v_mov_b32 v132, v108
    v_mov_b32 v133, v109
    v_mov_b32 v134, v110
    v_mov_b32 v135, v111
L_rw1_B:
    s_cmp_lg_u32 s78, 2
    s_cbranch_scc1 L_rw2_B
    ds_write_b128 v0, v[96:99] offset:0
    ds_write_b128 v0, v[100:103] offset:1024
    ds_write_b128 v0, v[104:107] offset:8192
    ds_write_b128 v0, v[108:111] offset:9216
    ds_write_b128 v0, v[120:123] offset:24576
    ds_write_b128 v0, v[124:127] offset:25600
    v_mov_b32 v128, v112
    v_mov_b32 v129, v113
    v_mov_b32 v130, v114
    v_mov_b32 v131, v115
    v_mov_b32 v132, v116
    v_mov_b32 v133, v117
    v_mov_b32 v134, v118
    v_mov_b32 v135, v119
L_rw2_B:
    s_cmp_lg_u32 s78, 3
    s_cbranch_scc1 L_rw3_B
    ds_write_b128 v0, v[96:99] offset:0
    ds_write_b128 v0, v[100:103] offset:1024
    ds_write_b128 v0, v[104:107] offset:8192
    ds_write_b128 v0, v[108:111] offset:9216
    ds_write_b128 v0, v[112:115] offset:16384
    ds_write_b128 v0, v[116:119] offset:17408
    v_mov_b32 v128, v120
    v_mov_b32 v129, v121
    v_mov_b32 v130, v122
    v_mov_b32 v131, v123
    v_mov_b32 v132, v124
    v_mov_b32 v133, v125
    v_mov_b32 v134, v126
    v_mov_b32 v135, v127
L_rw3_B:
    s_waitcnt lgkmcnt(0)
    s_barrier
    s_xor_b32 s53, s78, 1
    s_lshl_b32 s53, s53, 11
    s_lshl_b32 s52, s79, 15
    s_add_u32 s53, s53, s52
    s_lshl_b32 s52, s78, 13
    s_add_u32 s53, s53, s52
    v_add_u32 v81, s53, v2
    ds_read_b128 v[136:139], v81
    ds_read_b128 v[140:143], v81 offset:1024
    s_xor_b32 s53, s78, 2
    s_lshl_b32 s53, s53, 11
    s_lshl_b32 s52, s79, 15
    s_add_u32 s53, s53, s52
    s_lshl_b32 s52, s78, 13
    s_add_u32 s53, s53, s52
    v_add_u32 v82, s53, v2
    ds_read_b128 v[144:147], v82
    ds_read_b128 v[148:151], v82 offset:1024
    s_xor_b32 s53, s78, 3
    s_lshl_b32 s53, s53, 11
    s_lshl_b32 s52, s79, 15
    s_add_u32 s53, s53, s52
    s_lshl_b32 s52, s78, 13
    s_add_u32 s53, s53, s52
    v_add_u32 v83, s53, v2
    ds_read_b128 v[152:155], v83
    ds_read_b128 v[156:159], v83 offset:1024
    s_waitcnt lgkmcnt(5)
    v_add_f32 v128, v128, v136
    s_waitcnt lgkmcnt(1)
    v_add_f32 v144, v144, v152
    v_add_f32 v129, v129, v137
    v_add_f32 v145, v145, v153
    v_add_f32 v130, v130, v138
    v_add_f32 v146, v146, v154
    v_add_f32 v131, v131, v139
    v_add_f32 v147, v147, v155
    v_add_f32 v132, v132, v140
    s_waitcnt lgkmcnt(0)
    v_add_f32 v148, v148, v156
    v_add_f32 v133, v133, v141
    v_add_f32 v149, v149, v157
    v_add_f32 v134, v134, v142
    v_add_f32 v150, v150, v158
    v_add_f32 v135, v135, v143
    v_add_f32 v151, v151, v159
    v_add_f32 v128, v128, v144
    v_add_f32 v129, v129, v145
    v_add_f32 v130, v130, v146
    v_add_f32 v131, v131, v147
    v_add_f32 v132, v132, v148
    v_add_f32 v133, v133, v149
    v_add_f32 v134, v134, v150
    v_add_f32 v135, v135, v151
    v_lshlrev_b32 v136, 16, v6
    v_and_b32 v137, 0xffff0000, v6
    v_lshlrev_b32 v138, 16, v7
    v_and_b32 v139, 0xffff0000, v7
    v_add_f32 v128, v128, v136
    v_add_f32 v129, v129, v137
    v_add_f32 v130, v130, v138
    v_add_f32 v131, v131, v139
    v_lshlrev_b32 v136, 16, v14
    v_and_b32 v137, 0xffff0000, v14
    v_lshlrev_b32 v138, 16, v15
    v_and_b32 v139, 0xffff0000, v15
    v_add_f32 v132, v132, v136
    v_add_f32 v133, v133, v137
    v_add_f32 v134, v134, v138
    v_add_f32 v135, v135, v139
    v_cvt_pk_bf16_f32 v144, v128, v129
    v_cvt_pk_bf16_f32 v145, v130, v131
    v_cvt_pk_bf16_f32 v146, v132, v133
    v_cvt_pk_bf16_f32 v147, v134, v135
    v_and_b32 v0, 31, v1
    v_lshlrev_b32 v0, 10, v0
    v_lshrrev_b32 v3, 5, v1
    v_lshlrev_b32 v3, 4, v3
    v_add_u32 v0, v0, v3
    v_permlane32_swap_b32 v144, v146
    v_permlane32_swap_b32 v145, v147
    buffer_store_dwordx4 v[144:147], v0, s[28:31], s49 offen
    s_waitcnt vmcnt(0) lgkmcnt(0)
    s_endpgm
L_end:
    s_endpgm
.section .rodata,"a"
.p2align 6
.amdhsa_kernel parallel_sum__linear_attn_block__glu_gated_swiglu__prompt_kernel
  .amdhsa_next_free_vgpr 256
  .amdhsa_next_free_sgpr 102
  .amdhsa_accum_offset 256
  .amdhsa_group_segment_fixed_size 0
  .amdhsa_kernarg_size 80
  .amdhsa_user_sgpr_count 2
  .amdhsa_user_sgpr_kernarg_segment_ptr 1
  .amdhsa_system_sgpr_workgroup_id_x 1
.end_amdhsa_kernel
```
